```python
import torch

def _softmax(x, axis=-1):
    return torch.softmax(x, dim=axis)
def _gelu(x):
    return torch.nn.functional.gelu(x, approximate="tanh")
def _silu(x):
    return torch.nn.functional.silu(x)
def _sigmoid(x):
    return torch.sigmoid(x)
def _layernorm(x, axis=-1, eps=1e-5):
    m = x.mean(dim=axis, keepdim=True)
    v = x.var(dim=axis, keepdim=True, unbiased=False)
    return (x - m) / torch.sqrt(v + eps)
def _scatter_add(tgt, idx, src, axis=0):
    return tgt.clone().index_add_(axis, idx, src)
def _segment_sum(src, seg, n):
    out = torch.zeros((n,) + src.shape[1:], dtype=src.dtype)
    return out.index_add_(0, seg, src)
def _pad(x, pw):
    flat = tuple(v for pair in reversed(pw) for v in pair)
    return torch.nn.functional.pad(x, flat)

kernel_name = 'standalone__glu_gated_swiglu__sampling'

def setup_inputs():

    _w = (lambda a: (lambda t: t.to(torch.bfloat16) if t.is_floating_point() else t)(torch.as_tensor(a)))
    B, S, D, F = 32, 32, 512, 1792
    return {
        "x": _w((lambda *s: torch.randn(*s, dtype=torch.bfloat16) * 0.05)(B, S, D)),
        "w1": _w((lambda *s: torch.randn(*s, dtype=torch.bfloat16) * 0.05)(D, F) * (2.0 / D) ** 0.5),
        "w3": _w((lambda *s: torch.randn(*s, dtype=torch.bfloat16) * 0.05)(D, F) * (2.0 / D) ** 0.5),
        "w2": _w((lambda *s: torch.randn(*s, dtype=torch.bfloat16) * 0.05)(F, D) * (2.0 / F) ** 0.5),
    }

def reference(x, w1, w3, w2):
    gate = torch.einsum("bsd,df->bsf", x, w1)
    up = torch.einsum("bsd,df->bsf", x, w3)
    h = _silu(gate) * up
    out = torch.einsum("bsf,fd->bsd", h, w2)
    return out
```

```asm
; @launch grid=(256,1,1) block=(512,1,1) lds=163840
.amdgcn_target "amdgcn-amd-amdhsa--gfx950"
.text
.globl standalone__glu_gated_swiglu__sampling_kernel
.p2align 12
.type standalone__glu_gated_swiglu__sampling_kernel,@function
standalone__glu_gated_swiglu__sampling_kernel:

    s_cmp_ge_u32 s2, 256
    s_cbranch_scc1 L_done

    s_load_dwordx8 s[4:11], s[0:1], 0
    s_load_dwordx4 s[12:15], s[0:1], 32
    s_load_dwordx2 s[16:17], s[0:1], 48
    v_lshrrev_b32 v9, 6, v0
    v_and_b32 v10, 63, v0
    s_and_b32 s35, s2, 7
    v_readfirstlane_b32 s32, v9
    s_lshr_b32 s36, s2, 3
    s_and_b32 s37, s36, 3
    s_lshr_b32 s38, s36, 2
    s_and_b32 s33, s35, 1
    s_lshl_b32 s33, s33, 2
    s_add_u32 s33, s33, s37
    s_lshr_b32 s34, s35, 1
    s_mul_i32 s34, s34, 7
    s_add_u32 s34, s34, s38
    s_and_b32 s46, s32, 3
    s_cmp_lt_u32 s32, 4
    s_cbranch_scc1 L_compute

    v_lshrrev_b32 v11, 3, v10
    v_and_b32 v12, 7, v10
    v_lshrrev_b32 v13, 4, v10
    v_xor_b32 v14, v13, v12
    v_lshlrev_b32 v14, 4, v14
    v_lshl_add_u32 v16, v11, 10, v14
    s_lshl_b32 s41, s46, 15
    v_add_u32 v16, s41, v16
    v_xor_b32 v17, 64, v16
    v_add_u32 v18, 14336, v16
    v_add_u32 v19, 21504, v17
    v_add_u32 v17, 7168, v17
    v_and_b32 v14, 1, v13
    v_lshlrev_b32 v14, 2, v14
    v_xor_b32 v14, v14, v12
    v_lshlrev_b32 v14, 4, v14
    s_movk_i32 s41, 3584
    v_mul_lo_u32 v20, v11, s41
    v_add_u32 v20, v20, v14
    s_and_b32 s40, s46, 1
    s_mul_i32 s41, s40, 114688
    v_add_u32 v20, s41, v20
    v_add_u32 v21, 27648, v20
    v_add_u32 v22, 55296, v20
    v_add_u32 v23, 82944, v20
    s_lshl_b32 s62, s46, 12
    s_lshl_b32 s64, s37, 1
    s_add_u32 s64, s64, s38
    s_add_u32 s64, s64, s35
    s_and_b32 s64, s64, 7
    s_mov_b32 s67, 229376
    s_lshl_b32 s60, s64, 7
    s_mul_i32 s61, s64, s67
    s_mov_b32 s22, 0x20000
    s_mov_b32 s23, 0x20000
    s_lshl_b32 s19, s33, 17
    s_lshl_b32 s41, s34, 7
    s_sub_u32 s26, 1835008, s41
    s_mov_b32 s27, 0x20000

    s_and_b32 s44, s35, 1
    s_xor_b32 s44, s44, 1
    s_lshl_b32 s44, s44, 1
    s_bfe_u32 s45, s35, 0x10001
    s_add_u32 s44, s44, s45

    s_lshl_b32 s44, s44, 3
    s_add_u32 s44, s44, s38
    s_lshr_b32 s45, s35, 2
    s_lshl_b32 s45, s45, 2
    s_add_u32 s45, s45, s37

    s_cmp_eq_u32 s38, 7
    s_cselect_b32 s3, 0, s38
    s_cmp_ge_u32 s36, 28
    s_cbranch_scc1 L_hsetup

    s_cmp_lt_u32 s46, 2
    s_waitcnt lgkmcnt(0)
    s_cselect_b32 s24, s6, s8
    s_cselect_b32 s25, s7, s9
    s_add_u32 s20, s4, s19
    s_addc_u32 s21, s5, 0
    s_mov_b32 m0, s62
    s_add_u32 s24, s24, s41

    buffer_load_dwordx4 v16, s[20:23], s60 offen lds
    s_addc_u32 s25, s25, 0
    buffer_load_dwordx4 v17, s[20:23], s60 offen offset:1024 lds
    buffer_load_dwordx4 v18, s[20:23], s60 offen offset:2048 lds
    buffer_load_dwordx4 v19, s[20:23], s60 offen offset:3072 lds
    s_add_u32 m0, s62, 0x4000
    s_nop 0
    buffer_load_dwordx4 v20, s[24:27], s61 offen lds
    buffer_load_dwordx4 v21, s[24:27], s61 offen offset:1024 lds
    buffer_load_dwordx4 v22, s[24:27], s61 offen offset:2048 lds
    buffer_load_dwordx4 v23, s[24:27], s61 offen offset:3072 lds

    s_add_u32 s64, s64, 1
    s_and_b32 s64, s64, 7
    s_lshl_b32 s60, s64, 7
    s_mul_i32 s61, s64, s67
    s_add_u32 s62, s62, 0x8000
    s_sub_u32 s18, s62, 0x28000
    s_cselect_b32 s62, s62, s18

    s_mov_b32 m0, s62
    s_nop 0
    buffer_load_dwordx4 v16, s[20:23], s60 offen lds
    buffer_load_dwordx4 v17, s[20:23], s60 offen offset:1024 lds
    buffer_load_dwordx4 v18, s[20:23], s60 offen offset:2048 lds
    buffer_load_dwordx4 v19, s[20:23], s60 offen offset:3072 lds
    s_add_u32 m0, s62, 0x4000
    s_nop 0
    buffer_load_dwordx4 v20, s[24:27], s61 offen lds
    buffer_load_dwordx4 v21, s[24:27], s61 offen offset:1024 lds
    buffer_load_dwordx4 v22, s[24:27], s61 offen offset:2048 lds
    buffer_load_dwordx4 v23, s[24:27], s61 offen offset:3072 lds

    v_lshrrev_b32 v12, 5, v10
    v_bfe_u32 v11, v10, 2, 2
    v_lshl_add_u32 v13, v12, 2, v11
    v_lshlrev_b32 v14, 7, v13
    v_lshrrev_b32 v13, 1, v11
    v_lshl_add_u32 v14, v13, 6, v14
    v_bfe_u32 v13, v10, 4, 1
    v_lshl_add_u32 v14, v13, 5, v14
    v_and_b32 v13, 3, v10
    v_lshl_add_u32 v14, v13, 3, v14
    s_lshl_b32 s47, s46, 13

    s_add_u32 s18, s47, 0x18000
    v_add_u32 v27, s18, v14
    v_xor_b32 v31, 64, v27

    v_lshrrev_b32 v12, 3, v10
    v_cmp_lt_u32 vcc, 2, v12
    v_addc_co_u32 v12, vcc, 0, v12, vcc
    v_and_b32 v13, 7, v10
    v_lshlrev_b32 v13, 4, v13
    v_lshl_add_u32 v8, v12, 7, v13

    v_add_u32 v9, 4096, v8
    v_mov_b32 v15, 0

    v_lshrrev_b32 v12, 3, v10
    v_and_b32 v13, 7, v10
    v_bfe_u32 v14, v10, 4, 1
    v_lshlrev_b32 v14, 2, v14
    v_xor_b32 v14, v14, v13
    v_lshlrev_b32 v14, 4, v14
    v_lshl_add_u32 v32, v12, 10, v14
    s_lshl_b32 s18, s46, 16
    v_add_u32 v32, s18, v32

    v_add_u32 v33, 7168, v32
    v_add_u32 v34, 14336, v32
    v_add_u32 v35, 21504, v32
    v_add_u32 v36, 32768, v32
    v_add_u32 v37, 39936, v32
    v_add_u32 v38, 47104, v32
    v_add_u32 v39, 54272, v32

    s_lshl_b32 s18, s45, 7
    s_add_u32 s48, s10, s18
    s_addc_u32 s49, s11, 0
    s_sub_u32 s50, 1835008, s18
    s_mov_b32 s51, 0x20000

    s_mov_b32 s52, s14
    s_mov_b32 s53, s15
    s_mov_b32 s54, 256
    s_mov_b32 s55, 0x20000

    s_mov_b32 s28, s16
    s_mov_b32 s29, s17
    s_mov_b32 s30, 8404992
    s_mov_b32 s31, 0x20000

    s_mov_b32 s56, s12
    s_mov_b32 s57, s13
    s_mov_b32 s58, 0x100000
    s_mov_b32 s59, 0x20000
    s_lshl_b32 s43, s44, 15
    s_lshl_b32 s19, s45, 7
    s_add_u32 s43, s43, s19

    s_lshr_b32 s18, s44, 1
    s_lshl_b32 s18, s18, 2
    s_add_u32 s18, s18, s46
    s_mul_i32 s18, s18, 256
    s_add_u32 s18, s18, 8388608
    v_bfe_u32 v12, v10, 1, 2

    v_lshrrev_b32 v13, 1, v12
    v_mul_u32_u24 v13, 3, v13
    v_add_u32 v12, v12, v13

    v_add_u32 v12, s3, v12
    v_subrev_u32 v13, 7, v12
    v_min_u32 v12, v12, v13
    v_and_b32 v13, 1, v10
    v_lshl_add_u32 v12, v12, 1, v13
    v_lshlrev_b32 v12, 3, v12
    v_add_u32 v30, s18, v12

    s_mov_b32 s39, s37

    s_mul_i32 s18, s44, 112
    s_lshl_b32 s19, s46, 2
    s_add_u32 s18, s18, s19
    s_mul_i32 s18, s18, 2048

    s_add_u32 s19, s3, 0
    s_sub_u32 s33, s19, 7
    s_cselect_b32 s19, s19, s33
    s_mul_i32 s19, s19, 32768
    s_add_u32 s33, s18, s19

    s_add_u32 s19, s3, 1
    s_sub_u32 s34, s19, 7
    s_cselect_b32 s19, s19, s34
    s_mul_i32 s19, s19, 32768
    s_add_u32 s34, s18, s19

    s_add_u32 s19, s3, 5
    s_sub_u32 s35, s19, 7
    s_cselect_b32 s19, s19, s35
    s_mul_i32 s19, s19, 32768
    s_add_u32 s35, s18, s19

    s_add_u32 s19, s3, 6
    s_sub_u32 s37, s19, 7
    s_cselect_b32 s19, s19, s37
    s_mul_i32 s19, s19, 32768
    s_add_u32 s37, s18, s19

    v_and_b32 v11, 31, v10
    v_lshrrev_b32 v12, 5, v10
    v_and_b32 v13, 3, v11
    v_bfe_u32 v14, v11, 2, 1
    v_mul_u32_u24 v14, 12, v14
    v_or_b32 v13, v13, v14
    v_xor_b32 v13, v13, v12
    v_lshlrev_b32 v13, 4, v13
    v_lshl_add_u32 v13, v11, 8, v13
    s_lshl_b32 s18, s32, 13
    s_add_u32 s18, s18, 0x10000
    v_add_u32 v24, s18, v13
    v_lshrrev_b32 v11, 4, v10
    s_lshl_b32 s18, s32, 2
    v_add_u32 v11, s18, v11
    v_and_b32 v12, 15, v10
    v_and_b32 v13, 3, v11
    v_bfe_u32 v14, v11, 2, 1
    v_mul_u32_u24 v14, 12, v14
    v_or_b32 v13, v13, v14
    v_xor_b32 v13, v13, v12
    v_lshlrev_b32 v13, 4, v13
    v_lshl_add_u32 v13, v11, 8, v13
    v_add_u32 v25, 0x10000, v13
    v_lshlrev_b32 v26, 10, v11
    v_lshl_add_u32 v26, v12, 3, v26

    s_waitcnt vmcnt(8)
    s_barrier
    s_mov_b32 s65, 6
L_lloop:

    s_add_u32 s64, s64, 1
    s_and_b32 s64, s64, 7
    s_lshl_b32 s60, s64, 7
    s_mul_i32 s61, s64, s67
    s_add_u32 s62, s62, 0x8000
    s_sub_u32 s18, s62, 0x28000
    s_cselect_b32 s62, s62, s18

    s_mov_b32 m0, s62
    s_nop 0
    buffer_load_dwordx4 v16, s[20:23], s60 offen lds
    buffer_load_dwordx4 v17, s[20:23], s60 offen offset:1024 lds
    buffer_load_dwordx4 v18, s[20:23], s60 offen offset:2048 lds
    buffer_load_dwordx4 v19, s[20:23], s60 offen offset:3072 lds
    s_add_u32 m0, s62, 0x4000
    s_nop 0
    buffer_load_dwordx4 v20, s[24:27], s61 offen lds
    buffer_load_dwordx4 v21, s[24:27], s61 offen offset:1024 lds
    buffer_load_dwordx4 v22, s[24:27], s61 offen offset:2048 lds
    buffer_load_dwordx4 v23, s[24:27], s61 offen offset:3072 lds
    s_waitcnt vmcnt(8)
    s_sub_u32 s65, s65, 1
    s_barrier
    s_cmp_lg_u32 s65, 0
    s_cbranch_scc1 L_lloop
L_pieces:
    s_lshl_b32 s66, s3, 18
    s_add_u32 m0, s47, 98304
    s_nop 0
    buffer_load_dwordx4 v32, s[48:51], s66 offen lds
    buffer_load_dwordx4 v33, s[48:51], s66 offen offset:1024 lds
    buffer_load_dwordx4 v34, s[48:51], s66 offen offset:2048 lds
    buffer_load_dwordx4 v35, s[48:51], s66 offen offset:3072 lds
    s_addk_i32 m0, 0x1000
    s_nop 0
    buffer_load_dwordx4 v36, s[48:51], s66 offen lds
    buffer_load_dwordx4 v37, s[48:51], s66 offen offset:1024 lds
    buffer_load_dwordx4 v38, s[48:51], s66 offen offset:2048 lds
    buffer_load_dwordx4 v39, s[48:51], s66 offen offset:3072 lds

    s_add_u32 s66, s66, 262144
    s_cmp_eq_u32 s66, 1835008
    s_cselect_b32 s66, 0, s66

L_after_p0:
    s_cmp_ge_u32 s36, 28
    s_cbranch_scc1 L_skip0
    s_waitcnt vmcnt(8)
    s_barrier
L_skip0:
    s_add_u32 m0, s47, 131072
    s_nop 0
    buffer_load_dwordx4 v32, s[48:51], s66 offen lds
    buffer_load_dwordx4 v33, s[48:51], s66 offen offset:1024 lds
    buffer_load_dwordx4 v34, s[48:51], s66 offen offset:2048 lds
    buffer_load_dwordx4 v35, s[48:51], s66 offen offset:3072 lds
    s_cmp_ge_u32 s36, 28
    s_cbranch_scc1 L_skip1
    s_barrier
L_skip1:
    s_add_u32 m0, s47, 135168
    s_nop 0
    buffer_load_dwordx4 v36, s[48:51], s66 offen lds
    buffer_load_dwordx4 v37, s[48:51], s66 offen offset:1024 lds
    buffer_load_dwordx4 v38, s[48:51], s66 offen offset:2048 lds
    buffer_load_dwordx4 v39, s[48:51], s66 offen offset:3072 lds

    s_add_u32 s66, s66, 262144
    s_cmp_eq_u32 s66, 1835008
    s_cselect_b32 s66, 0, s66

    s_barrier
    s_add_u32 m0, s47, 0
    s_nop 0
    buffer_load_dwordx4 v32, s[48:51], s66 offen lds
    buffer_load_dwordx4 v33, s[48:51], s66 offen offset:1024 lds
    buffer_load_dwordx4 v34, s[48:51], s66 offen offset:2048 lds
    buffer_load_dwordx4 v35, s[48:51], s66 offen offset:3072 lds
    s_addk_i32 m0, 0x1000
    s_nop 0
    buffer_load_dwordx4 v36, s[48:51], s66 offen lds
    buffer_load_dwordx4 v37, s[48:51], s66 offen offset:1024 lds
    buffer_load_dwordx4 v38, s[48:51], s66 offen offset:2048 lds
    buffer_load_dwordx4 v39, s[48:51], s66 offen offset:3072 lds

    s_add_u32 s66, s66, 262144
    s_cmp_eq_u32 s66, 1835008
    s_cselect_b32 s66, 0, s66

    s_waitcnt vmcnt(16)
    buffer_load_dwordx2 v[28:29], v15, s[52:55], 0 offen sc1
    s_add_u32 m0, s47, 32768
    s_nop 0
    buffer_load_dwordx4 v32, s[48:51], s66 offen lds
    ds_read_b64_tr_b16 v[64:65], v27 offset:0
    ds_read_b64_tr_b16 v[66:67], v27 offset:1024
    buffer_load_dwordx4 v33, s[48:51], s66 offen offset:1024 lds
    ds_read_b64_tr_b16 v[68:69], v31 offset:0
    ds_read_b64_tr_b16 v[70:71], v31 offset:1024
    buffer_load_dwordx4 v34, s[48:51], s66 offen offset:2048 lds
    ds_read_b64_tr_b16 v[72:73], v27 offset:2048
    ds_read_b64_tr_b16 v[74:75], v27 offset:3072
    buffer_load_dwordx4 v35, s[48:51], s66 offen offset:3072 lds
    ds_read_b64_tr_b16 v[76:77], v31 offset:2048
    ds_read_b64_tr_b16 v[78:79], v31 offset:3072
    s_addk_i32 m0, 0x1000
    s_nop 0
    buffer_load_dwordx4 v36, s[48:51], s66 offen lds
    ds_read_b64_tr_b16 v[80:81], v27 offset:4096
    ds_read_b64_tr_b16 v[82:83], v27 offset:5120
    buffer_load_dwordx4 v37, s[48:51], s66 offen offset:1024 lds
    ds_read_b64_tr_b16 v[84:85], v31 offset:4096
    ds_read_b64_tr_b16 v[86:87], v31 offset:5120
    buffer_load_dwordx4 v38, s[48:51], s66 offen offset:2048 lds
    ds_read_b64_tr_b16 v[88:89], v27 offset:6144
    ds_read_b64_tr_b16 v[90:91], v27 offset:7168
    buffer_load_dwordx4 v39, s[48:51], s66 offen offset:3072 lds
    ds_read_b64_tr_b16 v[92:93], v31 offset:6144
    ds_read_b64_tr_b16 v[94:95], v31 offset:7168

    s_add_u32 s66, s66, 262144
    s_cmp_eq_u32 s66, 1835008
    s_cselect_b32 s66, 0, s66

    s_waitcnt vmcnt(17)
    s_add_u32 m0, s47, 65536
    s_nop 0
    buffer_load_dwordx4 v32, s[48:51], s66 offen lds
    ds_read_b64_tr_b16 v[96:97], v27 offset:32768
    ds_read_b64_tr_b16 v[98:99], v27 offset:33792
    buffer_load_dwordx4 v33, s[48:51], s66 offen offset:1024 lds
    ds_read_b64_tr_b16 v[100:101], v31 offset:32768
    ds_read_b64_tr_b16 v[102:103], v31 offset:33792
    buffer_load_dwordx4 v34, s[48:51], s66 offen offset:2048 lds
    ds_read_b64_tr_b16 v[104:105], v27 offset:34816
    ds_read_b64_tr_b16 v[106:107], v27 offset:35840
    buffer_load_dwordx4 v35, s[48:51], s66 offen offset:3072 lds
    ds_read_b64_tr_b16 v[108:109], v31 offset:34816
    ds_read_b64_tr_b16 v[110:111], v31 offset:35840
    s_addk_i32 m0, 0x1000
    s_nop 0
    buffer_load_dwordx4 v36, s[48:51], s66 offen lds
    ds_read_b64_tr_b16 v[112:113], v27 offset:36864
    ds_read_b64_tr_b16 v[114:115], v27 offset:37888
    buffer_load_dwordx4 v37, s[48:51], s66 offen offset:1024 lds
    ds_read_b64_tr_b16 v[116:117], v31 offset:36864
    ds_read_b64_tr_b16 v[118:119], v31 offset:37888
    buffer_load_dwordx4 v38, s[48:51], s66 offen offset:2048 lds
    ds_read_b64_tr_b16 v[120:121], v27 offset:38912
    ds_read_b64_tr_b16 v[122:123], v27 offset:39936
    buffer_load_dwordx4 v39, s[48:51], s66 offen offset:3072 lds
    ds_read_b64_tr_b16 v[124:125], v31 offset:38912
    ds_read_b64_tr_b16 v[126:127], v31 offset:39936

    s_add_u32 s66, s66, 262144
    s_cmp_eq_u32 s66, 1835008
    s_cselect_b32 s66, 0, s66

    s_waitcnt lgkmcnt(0)
    s_add_u32 m0, s47, 98304
    s_nop 0
    buffer_load_dwordx4 v32, s[48:51], s66 offen lds
    buffer_load_dwordx4 v33, s[48:51], s66 offen offset:1024 lds
    buffer_load_dwordx4 v34, s[48:51], s66 offen offset:2048 lds
    buffer_load_dwordx4 v35, s[48:51], s66 offen offset:3072 lds
    s_addk_i32 m0, 0x1000
    s_nop 0
    buffer_load_dwordx4 v36, s[48:51], s66 offen lds
    buffer_load_dwordx4 v37, s[48:51], s66 offen offset:1024 lds
    buffer_load_dwordx4 v38, s[48:51], s66 offen offset:2048 lds
    buffer_load_dwordx4 v39, s[48:51], s66 offen offset:3072 lds

    s_add_u32 s66, s66, 262144
    s_cmp_eq_u32 s66, 1835008
    s_cselect_b32 s66, 0, s66

    s_add_u32 m0, s47, 131072
    s_nop 0
    buffer_load_dwordx4 v32, s[48:51], s66 offen lds
    buffer_load_dwordx4 v33, s[48:51], s66 offen offset:1024 lds
    buffer_load_dwordx4 v34, s[48:51], s66 offen offset:2048 lds
    buffer_load_dwordx4 v35, s[48:51], s66 offen offset:3072 lds
    s_addk_i32 m0, 0x1000
    s_nop 0
    buffer_load_dwordx4 v36, s[48:51], s66 offen lds
    buffer_load_dwordx4 v37, s[48:51], s66 offen offset:1024 lds
    buffer_load_dwordx4 v38, s[48:51], s66 offen offset:2048 lds
    buffer_load_dwordx4 v39, s[48:51], s66 offen offset:3072 lds

    s_add_u32 s66, s66, 262144
    s_cmp_eq_u32 s66, 1835008
    s_cselect_b32 s66, 0, s66

    buffer_load_dwordx2 v[16:17], v30, s[28:31], 0 offen sc1
    v_mov_b64 v[32:33], 0
    v_mov_b64 v[34:35], 0
    v_mov_b64 v[36:37], 0
    v_mov_b64 v[38:39], 0
    v_mov_b64 v[40:41], 0
    v_mov_b64 v[42:43], 0
    v_mov_b64 v[44:45], 0
    v_mov_b64 v[46:47], 0
    v_mov_b64 v[48:49], 0
    v_mov_b64 v[50:51], 0
    v_mov_b64 v[52:53], 0
    v_mov_b64 v[54:55], 0
    v_mov_b64 v[56:57], 0
    v_mov_b64 v[58:59], 0
    v_mov_b64 v[60:61], 0
    v_mov_b64 v[62:63], 0
    s_mov_b32 s60, 0x55
    s_mov_b32 s63, 0x55
    s_mov_b32 s65, 0
    s_waitcnt vmcnt(17)
    s_movk_i32 s19, 2000
L_nL:
    v_readfirstlane_b32 s18, v28
    s_cmp_lg_u32 s18, 0
    s_cbranch_scc1 L_nokL
    s_sub_u32 s19, s19, 1
    s_cmp_eq_u32 s19, 0
    s_cbranch_scc1 L_nokL
    buffer_load_dwordx2 v[28:29], v15, s[52:55], 0 offen sc1
    s_waitcnt vmcnt(0)
    s_branch L_nL
L_nokL:
    s_barrier
L_tail:
    s_mov_b32 s62, 0
    s_movk_i32 s64, 20000
    s_mov_b32 s66, 1
L_tloop:
    s_waitcnt vmcnt(0)
    s_mov_b32 s61, 0
    s_cmp_eq_u32 s60, 0
    s_cbranch_scc1 L_tmf
    v_cmp_ne_u64 vcc, v[16:17], v[28:29]
    s_sub_u32 s64, s64, 1
    s_cselect_b32 s19, 0, -1
    s_lshr_b32 s18, vcc_lo, 1
    s_or_b32 s18, s18, vcc_lo
    s_and_b32 s18, s18, s19
    s_andn2_b32 s61, s60, s18
    s_and_b32 s60, s60, s18
    s_cmp_eq_u32 s61, s63
    s_cbranch_scc1 L_rs
    s_bitcmp1_b32 s61, 0
    s_cbranch_scc0 L_th0
    buffer_load_dwordx4 v[192:195], v8, s[28:31], s33 offen offset:0 sc1
    buffer_load_dwordx4 v[196:199], v8, s[28:31], s33 offen offset:2048 sc1
    buffer_load_dwordx4 v[200:203], v9, s[28:31], s33 offen offset:0 sc1
    buffer_load_dwordx4 v[204:207], v9, s[28:31], s33 offen offset:2048 sc1
L_th0:
    s_bitcmp1_b32 s61, 2
    s_cbranch_scc0 L_th1
    buffer_load_dwordx4 v[208:211], v8, s[28:31], s34 offen offset:0 sc1
    buffer_load_dwordx4 v[212:215], v8, s[28:31], s34 offen offset:2048 sc1
    buffer_load_dwordx4 v[216:219], v9, s[28:31], s34 offen offset:0 sc1
    buffer_load_dwordx4 v[220:223], v9, s[28:31], s34 offen offset:2048 sc1
L_th1:
    s_bitcmp1_b32 s61, 4
    s_cbranch_scc0 L_th2
    buffer_load_dwordx4 v[224:227], v8, s[28:31], s35 offen offset:0 sc1
    buffer_load_dwordx4 v[228:231], v8, s[28:31], s35 offen offset:2048 sc1
    buffer_load_dwordx4 v[232:235], v9, s[28:31], s35 offen offset:0 sc1
    buffer_load_dwordx4 v[236:239], v9, s[28:31], s35 offen offset:2048 sc1
L_th2:
    s_bitcmp1_b32 s61, 6
    s_cbranch_scc0 L_th3
    buffer_load_dwordx4 v[240:243], v8, s[28:31], s37 offen offset:0 sc1
    buffer_load_dwordx4 v[244:247], v8, s[28:31], s37 offen offset:2048 sc1
    buffer_load_dwordx4 v[248:251], v9, s[28:31], s37 offen offset:0 sc1
    buffer_load_dwordx4 v[252:255], v9, s[28:31], s37 offen offset:2048 sc1
L_th3:
    s_cmp_eq_u32 s60, 0
    s_cbranch_scc1 L_tnp
    buffer_load_dwordx2 v[16:17], v30, s[28:31], 0 offen sc1
L_tnp:
    s_cmp_eq_u32 s66, 0
    s_cbranch_scc1 L_tmf
    s_mov_b32 s66, 0
    s_cmp_eq_u32 s65, 0
    s_cbranch_scc1 L_td2
    ds_read_b64_tr_b16 v[96:97], v20 offset:0
    ds_read_b64_tr_b16 v[98:99], v20 offset:1024
    ds_read_b64_tr_b16 v[100:101], v21 offset:0
    ds_read_b64_tr_b16 v[102:103], v21 offset:1024
    ds_read_b64_tr_b16 v[104:105], v20 offset:2048
    ds_read_b64_tr_b16 v[106:107], v20 offset:3072
    ds_read_b64_tr_b16 v[108:109], v21 offset:2048
    ds_read_b64_tr_b16 v[110:111], v21 offset:3072
    ds_read_b64_tr_b16 v[112:113], v20 offset:4096
    ds_read_b64_tr_b16 v[114:115], v20 offset:5120
    ds_read_b64_tr_b16 v[116:117], v21 offset:4096
    ds_read_b64_tr_b16 v[118:119], v21 offset:5120
    ds_read_b64_tr_b16 v[120:121], v20 offset:6144
    ds_read_b64_tr_b16 v[122:123], v20 offset:7168
    ds_read_b64_tr_b16 v[124:125], v21 offset:6144
    ds_read_b64_tr_b16 v[126:127], v21 offset:7168
L_td2:
    ds_read_b64_tr_b16 v[128:129], v27 offset:0
    ds_read_b64_tr_b16 v[130:131], v27 offset:1024
    ds_read_b64_tr_b16 v[132:133], v31 offset:0
    ds_read_b64_tr_b16 v[134:135], v31 offset:1024
    ds_read_b64_tr_b16 v[136:137], v27 offset:2048
    ds_read_b64_tr_b16 v[138:139], v27 offset:3072
    ds_read_b64_tr_b16 v[140:141], v31 offset:2048
    ds_read_b64_tr_b16 v[142:143], v31 offset:3072
    ds_read_b64_tr_b16 v[144:145], v27 offset:4096
    ds_read_b64_tr_b16 v[146:147], v27 offset:5120
    ds_read_b64_tr_b16 v[148:149], v31 offset:4096
    ds_read_b64_tr_b16 v[150:151], v31 offset:5120
    ds_read_b64_tr_b16 v[152:153], v27 offset:6144
    ds_read_b64_tr_b16 v[154:155], v27 offset:7168
    ds_read_b64_tr_b16 v[156:157], v31 offset:6144
    ds_read_b64_tr_b16 v[158:159], v31 offset:7168
    ds_read_b64_tr_b16 v[160:161], v27 offset:32768
    ds_read_b64_tr_b16 v[162:163], v27 offset:33792
    ds_read_b64_tr_b16 v[164:165], v31 offset:32768
    ds_read_b64_tr_b16 v[166:167], v31 offset:33792
    ds_read_b64_tr_b16 v[168:169], v27 offset:34816
    ds_read_b64_tr_b16 v[170:171], v27 offset:35840
    ds_read_b64_tr_b16 v[172:173], v31 offset:34816
    ds_read_b64_tr_b16 v[174:175], v31 offset:35840
    ds_read_b64_tr_b16 v[176:177], v27 offset:36864
    ds_read_b64_tr_b16 v[178:179], v27 offset:37888
    ds_read_b64_tr_b16 v[180:181], v31 offset:36864
    ds_read_b64_tr_b16 v[182:183], v31 offset:37888
    ds_read_b64_tr_b16 v[184:185], v27 offset:38912
    ds_read_b64_tr_b16 v[186:187], v27 offset:39936
    ds_read_b64_tr_b16 v[188:189], v31 offset:38912
    ds_read_b64_tr_b16 v[190:191], v31 offset:39936
    s_waitcnt lgkmcnt(0)
L_tmf:
    s_bitcmp1_b32 s62, 0
    s_cbranch_scc0 L_tm0
    v_mfma_f32_32x32x16_bf16 v[32:47], v[64:67], v[192:195], v[32:47]
    v_mfma_f32_32x32x16_bf16 v[48:63], v[68:71], v[192:195], v[48:63]
    v_mfma_f32_32x32x16_bf16 v[32:47], v[72:75], v[196:199], v[32:47]
    v_mfma_f32_32x32x16_bf16 v[48:63], v[76:79], v[196:199], v[48:63]
    v_mfma_f32_32x32x16_bf16 v[32:47], v[80:83], v[200:203], v[32:47]
    v_mfma_f32_32x32x16_bf16 v[48:63], v[84:87], v[200:203], v[48:63]
    v_mfma_f32_32x32x16_bf16 v[32:47], v[88:91], v[204:207], v[32:47]
    v_mfma_f32_32x32x16_bf16 v[48:63], v[92:95], v[204:207], v[48:63]
L_tm0:
    s_bitcmp1_b32 s62, 2
    s_cbranch_scc0 L_tm1
    v_mfma_f32_32x32x16_bf16 v[32:47], v[96:99], v[208:211], v[32:47]
    v_mfma_f32_32x32x16_bf16 v[48:63], v[100:103], v[208:211], v[48:63]
    v_mfma_f32_32x32x16_bf16 v[32:47], v[104:107], v[212:215], v[32:47]
    v_mfma_f32_32x32x16_bf16 v[48:63], v[108:111], v[212:215], v[48:63]
    v_mfma_f32_32x32x16_bf16 v[32:47], v[112:115], v[216:219], v[32:47]
    v_mfma_f32_32x32x16_bf16 v[48:63], v[116:119], v[216:219], v[48:63]
    v_mfma_f32_32x32x16_bf16 v[32:47], v[120:123], v[220:223], v[32:47]
    v_mfma_f32_32x32x16_bf16 v[48:63], v[124:127], v[220:223], v[48:63]
L_tm1:
    s_bitcmp1_b32 s62, 4
    s_cbranch_scc0 L_tm2
    v_mfma_f32_32x32x16_bf16 v[32:47], v[128:131], v[224:227], v[32:47]
    v_mfma_f32_32x32x16_bf16 v[48:63], v[132:135], v[224:227], v[48:63]
    v_mfma_f32_32x32x16_bf16 v[32:47], v[136:139], v[228:231], v[32:47]
    v_mfma_f32_32x32x16_bf16 v[48:63], v[140:143], v[228:231], v[48:63]
    v_mfma_f32_32x32x16_bf16 v[32:47], v[144:147], v[232:235], v[32:47]
    v_mfma_f32_32x32x16_bf16 v[48:63], v[148:151], v[232:235], v[48:63]
    v_mfma_f32_32x32x16_bf16 v[32:47], v[152:155], v[236:239], v[32:47]
    v_mfma_f32_32x32x16_bf16 v[48:63], v[156:159], v[236:239], v[48:63]
L_tm2:
    s_bitcmp1_b32 s62, 6
    s_cbranch_scc0 L_tm3
    v_mfma_f32_32x32x16_bf16 v[32:47], v[160:163], v[240:243], v[32:47]
    v_mfma_f32_32x32x16_bf16 v[48:63], v[164:167], v[240:243], v[48:63]
    v_mfma_f32_32x32x16_bf16 v[32:47], v[168:171], v[244:247], v[32:47]
    v_mfma_f32_32x32x16_bf16 v[48:63], v[172:175], v[244:247], v[48:63]
    v_mfma_f32_32x32x16_bf16 v[32:47], v[176:179], v[248:251], v[32:47]
    v_mfma_f32_32x32x16_bf16 v[48:63], v[180:183], v[248:251], v[48:63]
    v_mfma_f32_32x32x16_bf16 v[32:47], v[184:187], v[252:255], v[32:47]
    v_mfma_f32_32x32x16_bf16 v[48:63], v[188:191], v[252:255], v[48:63]
L_tm3:
    s_mov_b32 s62, s61
    s_or_b32 s18, s62, s60
    s_cbranch_scc1 L_tloop
    s_branch L_tdone
L_rs:
    s_cmp_eq_u32 s39, 1
    s_cbranch_scc1 L_rsl1
    s_cmp_eq_u32 s39, 2
    s_cbranch_scc1 L_rsl2
    s_cmp_eq_u32 s39, 3
    s_cbranch_scc1 L_rsl3
    s_cmp_eq_u32 s39, 4
    s_cbranch_scc1 L_rsl4
    s_cmp_eq_u32 s39, 5
    s_cbranch_scc1 L_rsl5
    s_cmp_eq_u32 s39, 6
    s_cbranch_scc1 L_rsl6
L_rsl0:
    buffer_load_dwordx4 v[192:195], v8, s[28:31], s33 offen offset:0 sc1
    buffer_load_dwordx4 v[196:199], v8, s[28:31], s33 offen offset:2048 sc1
    buffer_load_dwordx4 v[200:203], v9, s[28:31], s33 offen offset:0 sc1
    buffer_load_dwordx4 v[204:207], v9, s[28:31], s33 offen offset:2048 sc1
    buffer_load_dwordx4 v[208:211], v8, s[28:31], s34 offen offset:0 sc1
    buffer_load_dwordx4 v[212:215], v8, s[28:31], s34 offen offset:2048 sc1
    buffer_load_dwordx4 v[216:219], v9, s[28:31], s34 offen offset:0 sc1
    buffer_load_dwordx4 v[220:223], v9, s[28:31], s34 offen offset:2048 sc1
    buffer_load_dwordx4 v[224:227], v8, s[28:31], s35 offen offset:0 sc1
    buffer_load_dwordx4 v[228:231], v8, s[28:31], s35 offen offset:2048 sc1
    buffer_load_dwordx4 v[232:235], v9, s[28:31], s35 offen offset:0 sc1
    buffer_load_dwordx4 v[236:239], v9, s[28:31], s35 offen offset:2048 sc1
    buffer_load_dwordx4 v[240:243], v8, s[28:31], s37 offen offset:0 sc1
    buffer_load_dwordx4 v[244:247], v8, s[28:31], s37 offen offset:2048 sc1
    buffer_load_dwordx4 v[248:251], v9, s[28:31], s37 offen offset:0 sc1
    buffer_load_dwordx4 v[252:255], v9, s[28:31], s37 offen offset:2048 sc1
    s_branch L_rsd
L_rsl1:
    buffer_load_dwordx4 v[208:211], v8, s[28:31], s34 offen offset:0 sc1
    buffer_load_dwordx4 v[212:215], v8, s[28:31], s34 offen offset:2048 sc1
    buffer_load_dwordx4 v[216:219], v9, s[28:31], s34 offen offset:0 sc1
    buffer_load_dwordx4 v[220:223], v9, s[28:31], s34 offen offset:2048 sc1
    buffer_load_dwordx4 v[224:227], v8, s[28:31], s35 offen offset:0 sc1
    buffer_load_dwordx4 v[228:231], v8, s[28:31], s35 offen offset:2048 sc1
    buffer_load_dwordx4 v[232:235], v9, s[28:31], s35 offen offset:0 sc1
    buffer_load_dwordx4 v[236:239], v9, s[28:31], s35 offen offset:2048 sc1
    buffer_load_dwordx4 v[240:243], v8, s[28:31], s37 offen offset:0 sc1
    buffer_load_dwordx4 v[244:247], v8, s[28:31], s37 offen offset:2048 sc1
    buffer_load_dwordx4 v[248:251], v9, s[28:31], s37 offen offset:0 sc1
    buffer_load_dwordx4 v[252:255], v9, s[28:31], s37 offen offset:2048 sc1
    buffer_load_dwordx4 v[192:195], v8, s[28:31], s33 offen offset:0 sc1
    buffer_load_dwordx4 v[196:199], v8, s[28:31], s33 offen offset:2048 sc1
    buffer_load_dwordx4 v[200:203], v9, s[28:31], s33 offen offset:0 sc1
    buffer_load_dwordx4 v[204:207], v9, s[28:31], s33 offen offset:2048 sc1
    s_branch L_rsd
L_rsl2:
    buffer_load_dwordx4 v[224:227], v8, s[28:31], s35 offen offset:0 sc1
    buffer_load_dwordx4 v[228:231], v8, s[28:31], s35 offen offset:2048 sc1
    buffer_load_dwordx4 v[232:235], v9, s[28:31], s35 offen offset:0 sc1
    buffer_load_dwordx4 v[236:239], v9, s[28:31], s35 offen offset:2048 sc1
    buffer_load_dwordx4 v[240:243], v8, s[28:31], s37 offen offset:0 sc1
    buffer_load_dwordx4 v[244:247], v8, s[28:31], s37 offen offset:2048 sc1
    buffer_load_dwordx4 v[248:251], v9, s[28:31], s37 offen offset:0 sc1
    buffer_load_dwordx4 v[252:255], v9, s[28:31], s37 offen offset:2048 sc1
    buffer_load_dwordx4 v[192:195], v8, s[28:31], s33 offen offset:0 sc1
    buffer_load_dwordx4 v[196:199], v8, s[28:31], s33 offen offset:2048 sc1
    buffer_load_dwordx4 v[200:203], v9, s[28:31], s33 offen offset:0 sc1
    buffer_load_dwordx4 v[204:207], v9, s[28:31], s33 offen offset:2048 sc1
    buffer_load_dwordx4 v[208:211], v8, s[28:31], s34 offen offset:0 sc1
    buffer_load_dwordx4 v[212:215], v8, s[28:31], s34 offen offset:2048 sc1
    buffer_load_dwordx4 v[216:219], v9, s[28:31], s34 offen offset:0 sc1
    buffer_load_dwordx4 v[220:223], v9, s[28:31], s34 offen offset:2048 sc1
    s_branch L_rsd
L_rsl3:
    buffer_load_dwordx4 v[240:243], v8, s[28:31], s37 offen offset:0 sc1
    buffer_load_dwordx4 v[244:247], v8, s[28:31], s37 offen offset:2048 sc1
    buffer_load_dwordx4 v[248:251], v9, s[28:31], s37 offen offset:0 sc1
    buffer_load_dwordx4 v[252:255], v9, s[28:31], s37 offen offset:2048 sc1
    buffer_load_dwordx4 v[192:195], v8, s[28:31], s33 offen offset:0 sc1
    buffer_load_dwordx4 v[196:199], v8, s[28:31], s33 offen offset:2048 sc1
    buffer_load_dwordx4 v[200:203], v9, s[28:31], s33 offen offset:0 sc1
    buffer_load_dwordx4 v[204:207], v9, s[28:31], s33 offen offset:2048 sc1
    buffer_load_dwordx4 v[208:211], v8, s[28:31], s34 offen offset:0 sc1
    buffer_load_dwordx4 v[212:215], v8, s[28:31], s34 offen offset:2048 sc1
    buffer_load_dwordx4 v[216:219], v9, s[28:31], s34 offen offset:0 sc1
    buffer_load_dwordx4 v[220:223], v9, s[28:31], s34 offen offset:2048 sc1
    buffer_load_dwordx4 v[224:227], v8, s[28:31], s35 offen offset:0 sc1
    buffer_load_dwordx4 v[228:231], v8, s[28:31], s35 offen offset:2048 sc1
    buffer_load_dwordx4 v[232:235], v9, s[28:31], s35 offen offset:0 sc1
    buffer_load_dwordx4 v[236:239], v9, s[28:31], s35 offen offset:2048 sc1
    s_branch L_rsd
L_rsl4:
    buffer_load_dwordx4 v[208:211], v8, s[28:31], s34 offen offset:0 sc1
    buffer_load_dwordx4 v[212:215], v8, s[28:31], s34 offen offset:2048 sc1
    buffer_load_dwordx4 v[216:219], v9, s[28:31], s34 offen offset:0 sc1
    buffer_load_dwordx4 v[220:223], v9, s[28:31], s34 offen offset:2048 sc1
    buffer_load_dwordx4 v[224:227], v8, s[28:31], s35 offen offset:0 sc1
    buffer_load_dwordx4 v[228:231], v8, s[28:31], s35 offen offset:2048 sc1
    buffer_load_dwordx4 v[232:235], v9, s[28:31], s35 offen offset:0 sc1
    buffer_load_dwordx4 v[236:239], v9, s[28:31], s35 offen offset:2048 sc1
    buffer_load_dwordx4 v[240:243], v8, s[28:31], s37 offen offset:0 sc1
    buffer_load_dwordx4 v[244:247], v8, s[28:31], s37 offen offset:2048 sc1
    buffer_load_dwordx4 v[248:251], v9, s[28:31], s37 offen offset:0 sc1
    buffer_load_dwordx4 v[252:255], v9, s[28:31], s37 offen offset:2048 sc1
    s_branch L_rsd
L_rsl5:
    buffer_load_dwordx4 v[224:227], v8, s[28:31], s35 offen offset:0 sc1
    buffer_load_dwordx4 v[228:231], v8, s[28:31], s35 offen offset:2048 sc1
    buffer_load_dwordx4 v[232:235], v9, s[28:31], s35 offen offset:0 sc1
    buffer_load_dwordx4 v[236:239], v9, s[28:31], s35 offen offset:2048 sc1
    buffer_load_dwordx4 v[240:243], v8, s[28:31], s37 offen offset:0 sc1
    buffer_load_dwordx4 v[244:247], v8, s[28:31], s37 offen offset:2048 sc1
    buffer_load_dwordx4 v[248:251], v9, s[28:31], s37 offen offset:0 sc1
    buffer_load_dwordx4 v[252:255], v9, s[28:31], s37 offen offset:2048 sc1
    buffer_load_dwordx4 v[208:211], v8, s[28:31], s34 offen offset:0 sc1
    buffer_load_dwordx4 v[212:215], v8, s[28:31], s34 offen offset:2048 sc1
    buffer_load_dwordx4 v[216:219], v9, s[28:31], s34 offen offset:0 sc1
    buffer_load_dwordx4 v[220:223], v9, s[28:31], s34 offen offset:2048 sc1
    s_branch L_rsd
L_rsl6:
    buffer_load_dwordx4 v[240:243], v8, s[28:31], s37 offen offset:0 sc1
    buffer_load_dwordx4 v[244:247], v8, s[28:31], s37 offen offset:2048 sc1
    buffer_load_dwordx4 v[248:251], v9, s[28:31], s37 offen offset:0 sc1
    buffer_load_dwordx4 v[252:255], v9, s[28:31], s37 offen offset:2048 sc1
    buffer_load_dwordx4 v[208:211], v8, s[28:31], s34 offen offset:0 sc1
    buffer_load_dwordx4 v[212:215], v8, s[28:31], s34 offen offset:2048 sc1
    buffer_load_dwordx4 v[216:219], v9, s[28:31], s34 offen offset:0 sc1
    buffer_load_dwordx4 v[220:223], v9, s[28:31], s34 offen offset:2048 sc1
    buffer_load_dwordx4 v[224:227], v8, s[28:31], s35 offen offset:0 sc1
    buffer_load_dwordx4 v[228:231], v8, s[28:31], s35 offen offset:2048 sc1
    buffer_load_dwordx4 v[232:235], v9, s[28:31], s35 offen offset:0 sc1
    buffer_load_dwordx4 v[236:239], v9, s[28:31], s35 offen offset:2048 sc1
L_rsd:
    s_cmp_eq_u32 s65, 0
    s_cbranch_scc1 L_rsd2
    ds_read_b64_tr_b16 v[96:97], v20 offset:0
    ds_read_b64_tr_b16 v[98:99], v20 offset:1024
    ds_read_b64_tr_b16 v[100:101], v21 offset:0
    ds_read_b64_tr_b16 v[102:103], v21 offset:1024
    ds_read_b64_tr_b16 v[104:105], v20 offset:2048
    ds_read_b64_tr_b16 v[106:107], v20 offset:3072
    ds_read_b64_tr_b16 v[108:109], v21 offset:2048
    ds_read_b64_tr_b16 v[110:111], v21 offset:3072
    ds_read_b64_tr_b16 v[112:113], v20 offset:4096
    ds_read_b64_tr_b16 v[114:115], v20 offset:5120
    ds_read_b64_tr_b16 v[116:117], v21 offset:4096
    ds_read_b64_tr_b16 v[118:119], v21 offset:5120
    ds_read_b64_tr_b16 v[120:121], v20 offset:6144
    ds_read_b64_tr_b16 v[122:123], v20 offset:7168
    ds_read_b64_tr_b16 v[124:125], v21 offset:6144
    ds_read_b64_tr_b16 v[126:127], v21 offset:7168
L_rsd2:
    ds_read_b64_tr_b16 v[128:129], v27 offset:0
    ds_read_b64_tr_b16 v[130:131], v27 offset:1024
    ds_read_b64_tr_b16 v[132:133], v31 offset:0
    ds_read_b64_tr_b16 v[134:135], v31 offset:1024
    ds_read_b64_tr_b16 v[136:137], v27 offset:2048
    ds_read_b64_tr_b16 v[138:139], v27 offset:3072
    ds_read_b64_tr_b16 v[140:141], v31 offset:2048
    ds_read_b64_tr_b16 v[142:143], v31 offset:3072
    ds_read_b64_tr_b16 v[144:145], v27 offset:4096
    ds_read_b64_tr_b16 v[146:147], v27 offset:5120
    ds_read_b64_tr_b16 v[148:149], v31 offset:4096
    ds_read_b64_tr_b16 v[150:151], v31 offset:5120
    ds_read_b64_tr_b16 v[152:153], v27 offset:6144
    ds_read_b64_tr_b16 v[154:155], v27 offset:7168
    ds_read_b64_tr_b16 v[156:157], v31 offset:6144
    ds_read_b64_tr_b16 v[158:159], v31 offset:7168
    ds_read_b64_tr_b16 v[160:161], v27 offset:32768
    ds_read_b64_tr_b16 v[162:163], v27 offset:33792
    ds_read_b64_tr_b16 v[164:165], v31 offset:32768
    ds_read_b64_tr_b16 v[166:167], v31 offset:33792
    ds_read_b64_tr_b16 v[168:169], v27 offset:34816
    ds_read_b64_tr_b16 v[170:171], v27 offset:35840
    ds_read_b64_tr_b16 v[172:173], v31 offset:34816
    ds_read_b64_tr_b16 v[174:175], v31 offset:35840
    ds_read_b64_tr_b16 v[176:177], v27 offset:36864
    ds_read_b64_tr_b16 v[178:179], v27 offset:37888
    ds_read_b64_tr_b16 v[180:181], v31 offset:36864
    ds_read_b64_tr_b16 v[182:183], v31 offset:37888
    ds_read_b64_tr_b16 v[184:185], v27 offset:38912
    ds_read_b64_tr_b16 v[186:187], v27 offset:39936
    ds_read_b64_tr_b16 v[188:189], v31 offset:38912
    ds_read_b64_tr_b16 v[190:191], v31 offset:39936
    s_cmp_eq_u32 s39, 1
    s_cbranch_scc1 L_rsm1
    s_cmp_eq_u32 s39, 2
    s_cbranch_scc1 L_rsm2
    s_cmp_eq_u32 s39, 3
    s_cbranch_scc1 L_rsm3
    s_cmp_eq_u32 s39, 4
    s_cbranch_scc1 L_rsm4
    s_cmp_eq_u32 s39, 5
    s_cbranch_scc1 L_rsm5
    s_cmp_eq_u32 s39, 6
    s_cbranch_scc1 L_rsm6
L_rsm0:
    s_waitcnt lgkmcnt(0)
    s_waitcnt vmcnt(15)
    v_mfma_f32_32x32x16_bf16 v[32:47], v[64:67], v[192:195], v[32:47]
    v_mfma_f32_32x32x16_bf16 v[48:63], v[68:71], v[192:195], v[48:63]
    s_waitcnt vmcnt(14)
    v_mfma_f32_32x32x16_bf16 v[32:47], v[72:75], v[196:199], v[32:47]
    v_mfma_f32_32x32x16_bf16 v[48:63], v[76:79], v[196:199], v[48:63]
    s_waitcnt vmcnt(13)
    v_mfma_f32_32x32x16_bf16 v[32:47], v[80:83], v[200:203], v[32:47]
    v_mfma_f32_32x32x16_bf16 v[48:63], v[84:87], v[200:203], v[48:63]
    s_waitcnt vmcnt(12)
    v_mfma_f32_32x32x16_bf16 v[32:47], v[88:91], v[204:207], v[32:47]
    v_mfma_f32_32x32x16_bf16 v[48:63], v[92:95], v[204:207], v[48:63]
    s_waitcnt vmcnt(11)
    v_mfma_f32_32x32x16_bf16 v[32:47], v[96:99], v[208:211], v[32:47]
    v_mfma_f32_32x32x16_bf16 v[48:63], v[100:103], v[208:211], v[48:63]
    s_waitcnt vmcnt(10)
    v_mfma_f32_32x32x16_bf16 v[32:47], v[104:107], v[212:215], v[32:47]
    v_mfma_f32_32x32x16_bf16 v[48:63], v[108:111], v[212:215], v[48:63]
    s_waitcnt vmcnt(9)
    v_mfma_f32_32x32x16_bf16 v[32:47], v[112:115], v[216:219], v[32:47]
    v_mfma_f32_32x32x16_bf16 v[48:63], v[116:119], v[216:219], v[48:63]
    s_waitcnt vmcnt(8)
    v_mfma_f32_32x32x16_bf16 v[32:47], v[120:123], v[220:223], v[32:47]
    v_mfma_f32_32x32x16_bf16 v[48:63], v[124:127], v[220:223], v[48:63]
    s_waitcnt vmcnt(7)
    v_mfma_f32_32x32x16_bf16 v[32:47], v[128:131], v[224:227], v[32:47]
    v_mfma_f32_32x32x16_bf16 v[48:63], v[132:135], v[224:227], v[48:63]
    s_waitcnt vmcnt(6)
    v_mfma_f32_32x32x16_bf16 v[32:47], v[136:139], v[228:231], v[32:47]
    v_mfma_f32_32x32x16_bf16 v[48:63], v[140:143], v[228:231], v[48:63]
    s_waitcnt vmcnt(5)
    v_mfma_f32_32x32x16_bf16 v[32:47], v[144:147], v[232:235], v[32:47]
    v_mfma_f32_32x32x16_bf16 v[48:63], v[148:151], v[232:235], v[48:63]
    s_waitcnt vmcnt(4)
    v_mfma_f32_32x32x16_bf16 v[32:47], v[152:155], v[236:239], v[32:47]
    v_mfma_f32_32x32x16_bf16 v[48:63], v[156:159], v[236:239], v[48:63]
    s_waitcnt vmcnt(3)
    v_mfma_f32_32x32x16_bf16 v[32:47], v[160:163], v[240:243], v[32:47]
    v_mfma_f32_32x32x16_bf16 v[48:63], v[164:167], v[240:243], v[48:63]
    s_waitcnt vmcnt(2)
    v_mfma_f32_32x32x16_bf16 v[32:47], v[168:171], v[244:247], v[32:47]
    v_mfma_f32_32x32x16_bf16 v[48:63], v[172:175], v[244:247], v[48:63]
    s_waitcnt vmcnt(1)
    v_mfma_f32_32x32x16_bf16 v[32:47], v[176:179], v[248:251], v[32:47]
    v_mfma_f32_32x32x16_bf16 v[48:63], v[180:183], v[248:251], v[48:63]
    s_waitcnt vmcnt(0)
    v_mfma_f32_32x32x16_bf16 v[32:47], v[184:187], v[252:255], v[32:47]
    v_mfma_f32_32x32x16_bf16 v[48:63], v[188:191], v[252:255], v[48:63]
    s_branch L_tdone
L_rsm1:
    s_waitcnt lgkmcnt(0)
    s_waitcnt vmcnt(15)
    v_mfma_f32_32x32x16_bf16 v[32:47], v[96:99], v[208:211], v[32:47]
    v_mfma_f32_32x32x16_bf16 v[48:63], v[100:103], v[208:211], v[48:63]
    s_waitcnt vmcnt(14)
    v_mfma_f32_32x32x16_bf16 v[32:47], v[104:107], v[212:215], v[32:47]
    v_mfma_f32_32x32x16_bf16 v[48:63], v[108:111], v[212:215], v[48:63]
    s_waitcnt vmcnt(13)
    v_mfma_f32_32x32x16_bf16 v[32:47], v[112:115], v[216:219], v[32:47]
    v_mfma_f32_32x32x16_bf16 v[48:63], v[116:119], v[216:219], v[48:63]
    s_waitcnt vmcnt(12)
    v_mfma_f32_32x32x16_bf16 v[32:47], v[120:123], v[220:223], v[32:47]
    v_mfma_f32_32x32x16_bf16 v[48:63], v[124:127], v[220:223], v[48:63]
    s_waitcnt vmcnt(11)
    v_mfma_f32_32x32x16_bf16 v[32:47], v[128:131], v[224:227], v[32:47]
    v_mfma_f32_32x32x16_bf16 v[48:63], v[132:135], v[224:227], v[48:63]
    s_waitcnt vmcnt(10)
    v_mfma_f32_32x32x16_bf16 v[32:47], v[136:139], v[228:231], v[32:47]
    v_mfma_f32_32x32x16_bf16 v[48:63], v[140:143], v[228:231], v[48:63]
    s_waitcnt vmcnt(9)
    v_mfma_f32_32x32x16_bf16 v[32:47], v[144:147], v[232:235], v[32:47]
    v_mfma_f32_32x32x16_bf16 v[48:63], v[148:151], v[232:235], v[48:63]
    s_waitcnt vmcnt(8)
    v_mfma_f32_32x32x16_bf16 v[32:47], v[152:155], v[236:239], v[32:47]
    v_mfma_f32_32x32x16_bf16 v[48:63], v[156:159], v[236:239], v[48:63]
    s_waitcnt vmcnt(7)
    v_mfma_f32_32x32x16_bf16 v[32:47], v[160:163], v[240:243], v[32:47]
    v_mfma_f32_32x32x16_bf16 v[48:63], v[164:167], v[240:243], v[48:63]
    s_waitcnt vmcnt(6)
    v_mfma_f32_32x32x16_bf16 v[32:47], v[168:171], v[244:247], v[32:47]
    v_mfma_f32_32x32x16_bf16 v[48:63], v[172:175], v[244:247], v[48:63]
    s_waitcnt vmcnt(5)
    v_mfma_f32_32x32x16_bf16 v[32:47], v[176:179], v[248:251], v[32:47]
    v_mfma_f32_32x32x16_bf16 v[48:63], v[180:183], v[248:251], v[48:63]
    s_waitcnt vmcnt(4)
    v_mfma_f32_32x32x16_bf16 v[32:47], v[184:187], v[252:255], v[32:47]
    v_mfma_f32_32x32x16_bf16 v[48:63], v[188:191], v[252:255], v[48:63]
    s_waitcnt vmcnt(3)
    v_mfma_f32_32x32x16_bf16 v[32:47], v[64:67], v[192:195], v[32:47]
    v_mfma_f32_32x32x16_bf16 v[48:63], v[68:71], v[192:195], v[48:63]
    s_waitcnt vmcnt(2)
    v_mfma_f32_32x32x16_bf16 v[32:47], v[72:75], v[196:199], v[32:47]
    v_mfma_f32_32x32x16_bf16 v[48:63], v[76:79], v[196:199], v[48:63]
    s_waitcnt vmcnt(1)
    v_mfma_f32_32x32x16_bf16 v[32:47], v[80:83], v[200:203], v[32:47]
    v_mfma_f32_32x32x16_bf16 v[48:63], v[84:87], v[200:203], v[48:63]
    s_waitcnt vmcnt(0)
    v_mfma_f32_32x32x16_bf16 v[32:47], v[88:91], v[204:207], v[32:47]
    v_mfma_f32_32x32x16_bf16 v[48:63], v[92:95], v[204:207], v[48:63]
    s_branch L_tdone
L_rsm2:
    s_waitcnt lgkmcnt(0)
    s_waitcnt vmcnt(15)
    v_mfma_f32_32x32x16_bf16 v[32:47], v[128:131], v[224:227], v[32:47]
    v_mfma_f32_32x32x16_bf16 v[48:63], v[132:135], v[224:227], v[48:63]
    s_waitcnt vmcnt(14)
    v_mfma_f32_32x32x16_bf16 v[32:47], v[136:139], v[228:231], v[32:47]
    v_mfma_f32_32x32x16_bf16 v[48:63], v[140:143], v[228:231], v[48:63]
    s_waitcnt vmcnt(13)
    v_mfma_f32_32x32x16_bf16 v[32:47], v[144:147], v[232:235], v[32:47]
    v_mfma_f32_32x32x16_bf16 v[48:63], v[148:151], v[232:235], v[48:63]
    s_waitcnt vmcnt(12)
    v_mfma_f32_32x32x16_bf16 v[32:47], v[152:155], v[236:239], v[32:47]
    v_mfma_f32_32x32x16_bf16 v[48:63], v[156:159], v[236:239], v[48:63]
    s_waitcnt vmcnt(11)
    v_mfma_f32_32x32x16_bf16 v[32:47], v[160:163], v[240:243], v[32:47]
    v_mfma_f32_32x32x16_bf16 v[48:63], v[164:167], v[240:243], v[48:63]
    s_waitcnt vmcnt(10)
    v_mfma_f32_32x32x16_bf16 v[32:47], v[168:171], v[244:247], v[32:47]
    v_mfma_f32_32x32x16_bf16 v[48:63], v[172:175], v[244:247], v[48:63]
    s_waitcnt vmcnt(9)
    v_mfma_f32_32x32x16_bf16 v[32:47], v[176:179], v[248:251], v[32:47]
    v_mfma_f32_32x32x16_bf16 v[48:63], v[180:183], v[248:251], v[48:63]
    s_waitcnt vmcnt(8)
    v_mfma_f32_32x32x16_bf16 v[32:47], v[184:187], v[252:255], v[32:47]
    v_mfma_f32_32x32x16_bf16 v[48:63], v[188:191], v[252:255], v[48:63]
    s_waitcnt vmcnt(7)
    v_mfma_f32_32x32x16_bf16 v[32:47], v[64:67], v[192:195], v[32:47]
    v_mfma_f32_32x32x16_bf16 v[48:63], v[68:71], v[192:195], v[48:63]
    s_waitcnt vmcnt(6)
    v_mfma_f32_32x32x16_bf16 v[32:47], v[72:75], v[196:199], v[32:47]
    v_mfma_f32_32x32x16_bf16 v[48:63], v[76:79], v[196:199], v[48:63]
    s_waitcnt vmcnt(5)
    v_mfma_f32_32x32x16_bf16 v[32:47], v[80:83], v[200:203], v[32:47]
    v_mfma_f32_32x32x16_bf16 v[48:63], v[84:87], v[200:203], v[48:63]
    s_waitcnt vmcnt(4)
    v_mfma_f32_32x32x16_bf16 v[32:47], v[88:91], v[204:207], v[32:47]
    v_mfma_f32_32x32x16_bf16 v[48:63], v[92:95], v[204:207], v[48:63]
    s_waitcnt vmcnt(3)
    v_mfma_f32_32x32x16_bf16 v[32:47], v[96:99], v[208:211], v[32:47]
    v_mfma_f32_32x32x16_bf16 v[48:63], v[100:103], v[208:211], v[48:63]
    s_waitcnt vmcnt(2)
    v_mfma_f32_32x32x16_bf16 v[32:47], v[104:107], v[212:215], v[32:47]
    v_mfma_f32_32x32x16_bf16 v[48:63], v[108:111], v[212:215], v[48:63]
    s_waitcnt vmcnt(1)
    v_mfma_f32_32x32x16_bf16 v[32:47], v[112:115], v[216:219], v[32:47]
    v_mfma_f32_32x32x16_bf16 v[48:63], v[116:119], v[216:219], v[48:63]
    s_waitcnt vmcnt(0)
    v_mfma_f32_32x32x16_bf16 v[32:47], v[120:123], v[220:223], v[32:47]
    v_mfma_f32_32x32x16_bf16 v[48:63], v[124:127], v[220:223], v[48:63]
    s_branch L_tdone
L_rsm3:
    s_waitcnt lgkmcnt(0)
    s_waitcnt vmcnt(15)
    v_mfma_f32_32x32x16_bf16 v[32:47], v[160:163], v[240:243], v[32:47]
    v_mfma_f32_32x32x16_bf16 v[48:63], v[164:167], v[240:243], v[48:63]
    s_waitcnt vmcnt(14)
    v_mfma_f32_32x32x16_bf16 v[32:47], v[168:171], v[244:247], v[32:47]
    v_mfma_f32_32x32x16_bf16 v[48:63], v[172:175], v[244:247], v[48:63]
    s_waitcnt vmcnt(13)
    v_mfma_f32_32x32x16_bf16 v[32:47], v[176:179], v[248:251], v[32:47]
    v_mfma_f32_32x32x16_bf16 v[48:63], v[180:183], v[248:251], v[48:63]
    s_waitcnt vmcnt(12)
    v_mfma_f32_32x32x16_bf16 v[32:47], v[184:187], v[252:255], v[32:47]
    v_mfma_f32_32x32x16_bf16 v[48:63], v[188:191], v[252:255], v[48:63]
    s_waitcnt vmcnt(11)
    v_mfma_f32_32x32x16_bf16 v[32:47], v[64:67], v[192:195], v[32:47]
    v_mfma_f32_32x32x16_bf16 v[48:63], v[68:71], v[192:195], v[48:63]
    s_waitcnt vmcnt(10)
    v_mfma_f32_32x32x16_bf16 v[32:47], v[72:75], v[196:199], v[32:47]
    v_mfma_f32_32x32x16_bf16 v[48:63], v[76:79], v[196:199], v[48:63]
    s_waitcnt vmcnt(9)
    v_mfma_f32_32x32x16_bf16 v[32:47], v[80:83], v[200:203], v[32:47]
    v_mfma_f32_32x32x16_bf16 v[48:63], v[84:87], v[200:203], v[48:63]
    s_waitcnt vmcnt(8)
    v_mfma_f32_32x32x16_bf16 v[32:47], v[88:91], v[204:207], v[32:47]
    v_mfma_f32_32x32x16_bf16 v[48:63], v[92:95], v[204:207], v[48:63]
    s_waitcnt vmcnt(7)
    v_mfma_f32_32x32x16_bf16 v[32:47], v[96:99], v[208:211], v[32:47]
    v_mfma_f32_32x32x16_bf16 v[48:63], v[100:103], v[208:211], v[48:63]
    s_waitcnt vmcnt(6)
    v_mfma_f32_32x32x16_bf16 v[32:47], v[104:107], v[212:215], v[32:47]
    v_mfma_f32_32x32x16_bf16 v[48:63], v[108:111], v[212:215], v[48:63]
    s_waitcnt vmcnt(5)
    v_mfma_f32_32x32x16_bf16 v[32:47], v[112:115], v[216:219], v[32:47]
    v_mfma_f32_32x32x16_bf16 v[48:63], v[116:119], v[216:219], v[48:63]
    s_waitcnt vmcnt(4)
    v_mfma_f32_32x32x16_bf16 v[32:47], v[120:123], v[220:223], v[32:47]
    v_mfma_f32_32x32x16_bf16 v[48:63], v[124:127], v[220:223], v[48:63]
    s_waitcnt vmcnt(3)
    v_mfma_f32_32x32x16_bf16 v[32:47], v[128:131], v[224:227], v[32:47]
    v_mfma_f32_32x32x16_bf16 v[48:63], v[132:135], v[224:227], v[48:63]
    s_waitcnt vmcnt(2)
    v_mfma_f32_32x32x16_bf16 v[32:47], v[136:139], v[228:231], v[32:47]
    v_mfma_f32_32x32x16_bf16 v[48:63], v[140:143], v[228:231], v[48:63]
    s_waitcnt vmcnt(1)
    v_mfma_f32_32x32x16_bf16 v[32:47], v[144:147], v[232:235], v[32:47]
    v_mfma_f32_32x32x16_bf16 v[48:63], v[148:151], v[232:235], v[48:63]
    s_waitcnt vmcnt(0)
    v_mfma_f32_32x32x16_bf16 v[32:47], v[152:155], v[236:239], v[32:47]
    v_mfma_f32_32x32x16_bf16 v[48:63], v[156:159], v[236:239], v[48:63]
    s_branch L_tdone
L_rsm4:
    s_waitcnt lgkmcnt(0)
    s_waitcnt vmcnt(11)
    v_mfma_f32_32x32x16_bf16 v[32:47], v[96:99], v[208:211], v[32:47]
    v_mfma_f32_32x32x16_bf16 v[48:63], v[100:103], v[208:211], v[48:63]
    s_waitcnt vmcnt(10)
    v_mfma_f32_32x32x16_bf16 v[32:47], v[104:107], v[212:215], v[32:47]
    v_mfma_f32_32x32x16_bf16 v[48:63], v[108:111], v[212:215], v[48:63]
    s_waitcnt vmcnt(9)
    v_mfma_f32_32x32x16_bf16 v[32:47], v[112:115], v[216:219], v[32:47]
    v_mfma_f32_32x32x16_bf16 v[48:63], v[116:119], v[216:219], v[48:63]
    s_waitcnt vmcnt(8)
    v_mfma_f32_32x32x16_bf16 v[32:47], v[120:123], v[220:223], v[32:47]
    v_mfma_f32_32x32x16_bf16 v[48:63], v[124:127], v[220:223], v[48:63]
    s_waitcnt vmcnt(7)
    v_mfma_f32_32x32x16_bf16 v[32:47], v[128:131], v[224:227], v[32:47]
    v_mfma_f32_32x32x16_bf16 v[48:63], v[132:135], v[224:227], v[48:63]
    s_waitcnt vmcnt(6)
    v_mfma_f32_32x32x16_bf16 v[32:47], v[136:139], v[228:231], v[32:47]
    v_mfma_f32_32x32x16_bf16 v[48:63], v[140:143], v[228:231], v[48:63]
    s_waitcnt vmcnt(5)
    v_mfma_f32_32x32x16_bf16 v[32:47], v[144:147], v[232:235], v[32:47]
    v_mfma_f32_32x32x16_bf16 v[48:63], v[148:151], v[232:235], v[48:63]
    s_waitcnt vmcnt(4)
    v_mfma_f32_32x32x16_bf16 v[32:47], v[152:155], v[236:239], v[32:47]
    v_mfma_f32_32x32x16_bf16 v[48:63], v[156:159], v[236:239], v[48:63]
    s_waitcnt vmcnt(3)
    v_mfma_f32_32x32x16_bf16 v[32:47], v[160:163], v[240:243], v[32:47]
    v_mfma_f32_32x32x16_bf16 v[48:63], v[164:167], v[240:243], v[48:63]
    s_waitcnt vmcnt(2)
    v_mfma_f32_32x32x16_bf16 v[32:47], v[168:171], v[244:247], v[32:47]
    v_mfma_f32_32x32x16_bf16 v[48:63], v[172:175], v[244:247], v[48:63]
    s_waitcnt vmcnt(1)
    v_mfma_f32_32x32x16_bf16 v[32:47], v[176:179], v[248:251], v[32:47]
    v_mfma_f32_32x32x16_bf16 v[48:63], v[180:183], v[248:251], v[48:63]
    s_waitcnt vmcnt(0)
    v_mfma_f32_32x32x16_bf16 v[32:47], v[184:187], v[252:255], v[32:47]
    v_mfma_f32_32x32x16_bf16 v[48:63], v[188:191], v[252:255], v[48:63]
    s_branch L_tdone
L_rsm5:
    s_waitcnt lgkmcnt(0)
    s_waitcnt vmcnt(11)
    v_mfma_f32_32x32x16_bf16 v[32:47], v[128:131], v[224:227], v[32:47]
    v_mfma_f32_32x32x16_bf16 v[48:63], v[132:135], v[224:227], v[48:63]
    s_waitcnt vmcnt(10)
    v_mfma_f32_32x32x16_bf16 v[32:47], v[136:139], v[228:231], v[32:47]
    v_mfma_f32_32x32x16_bf16 v[48:63], v[140:143], v[228:231], v[48:63]
    s_waitcnt vmcnt(9)
    v_mfma_f32_32x32x16_bf16 v[32:47], v[144:147], v[232:235], v[32:47]
    v_mfma_f32_32x32x16_bf16 v[48:63], v[148:151], v[232:235], v[48:63]
    s_waitcnt vmcnt(8)
    v_mfma_f32_32x32x16_bf16 v[32:47], v[152:155], v[236:239], v[32:47]
    v_mfma_f32_32x32x16_bf16 v[48:63], v[156:159], v[236:239], v[48:63]
    s_waitcnt vmcnt(7)
    v_mfma_f32_32x32x16_bf16 v[32:47], v[160:163], v[240:243], v[32:47]
    v_mfma_f32_32x32x16_bf16 v[48:63], v[164:167], v[240:243], v[48:63]
    s_waitcnt vmcnt(6)
    v_mfma_f32_32x32x16_bf16 v[32:47], v[168:171], v[244:247], v[32:47]
    v_mfma_f32_32x32x16_bf16 v[48:63], v[172:175], v[244:247], v[48:63]
    s_waitcnt vmcnt(5)
    v_mfma_f32_32x32x16_bf16 v[32:47], v[176:179], v[248:251], v[32:47]
    v_mfma_f32_32x32x16_bf16 v[48:63], v[180:183], v[248:251], v[48:63]
    s_waitcnt vmcnt(4)
    v_mfma_f32_32x32x16_bf16 v[32:47], v[184:187], v[252:255], v[32:47]
    v_mfma_f32_32x32x16_bf16 v[48:63], v[188:191], v[252:255], v[48:63]
    s_waitcnt vmcnt(3)
    v_mfma_f32_32x32x16_bf16 v[32:47], v[96:99], v[208:211], v[32:47]
    v_mfma_f32_32x32x16_bf16 v[48:63], v[100:103], v[208:211], v[48:63]
    s_waitcnt vmcnt(2)
    v_mfma_f32_32x32x16_bf16 v[32:47], v[104:107], v[212:215], v[32:47]
    v_mfma_f32_32x32x16_bf16 v[48:63], v[108:111], v[212:215], v[48:63]
    s_waitcnt vmcnt(1)
    v_mfma_f32_32x32x16_bf16 v[32:47], v[112:115], v[216:219], v[32:47]
    v_mfma_f32_32x32x16_bf16 v[48:63], v[116:119], v[216:219], v[48:63]
    s_waitcnt vmcnt(0)
    v_mfma_f32_32x32x16_bf16 v[32:47], v[120:123], v[220:223], v[32:47]
    v_mfma_f32_32x32x16_bf16 v[48:63], v[124:127], v[220:223], v[48:63]
    s_branch L_tdone
L_rsm6:
    s_waitcnt lgkmcnt(0)
    s_waitcnt vmcnt(11)
    v_mfma_f32_32x32x16_bf16 v[32:47], v[160:163], v[240:243], v[32:47]
    v_mfma_f32_32x32x16_bf16 v[48:63], v[164:167], v[240:243], v[48:63]
    s_waitcnt vmcnt(10)
    v_mfma_f32_32x32x16_bf16 v[32:47], v[168:171], v[244:247], v[32:47]
    v_mfma_f32_32x32x16_bf16 v[48:63], v[172:175], v[244:247], v[48:63]
    s_waitcnt vmcnt(9)
    v_mfma_f32_32x32x16_bf16 v[32:47], v[176:179], v[248:251], v[32:47]
    v_mfma_f32_32x32x16_bf16 v[48:63], v[180:183], v[248:251], v[48:63]
    s_waitcnt vmcnt(8)
    v_mfma_f32_32x32x16_bf16 v[32:47], v[184:187], v[252:255], v[32:47]
    v_mfma_f32_32x32x16_bf16 v[48:63], v[188:191], v[252:255], v[48:63]
    s_waitcnt vmcnt(7)
    v_mfma_f32_32x32x16_bf16 v[32:47], v[96:99], v[208:211], v[32:47]
    v_mfma_f32_32x32x16_bf16 v[48:63], v[100:103], v[208:211], v[48:63]
    s_waitcnt vmcnt(6)
    v_mfma_f32_32x32x16_bf16 v[32:47], v[104:107], v[212:215], v[32:47]
    v_mfma_f32_32x32x16_bf16 v[48:63], v[108:111], v[212:215], v[48:63]
    s_waitcnt vmcnt(5)
    v_mfma_f32_32x32x16_bf16 v[32:47], v[112:115], v[216:219], v[32:47]
    v_mfma_f32_32x32x16_bf16 v[48:63], v[116:119], v[216:219], v[48:63]
    s_waitcnt vmcnt(4)
    v_mfma_f32_32x32x16_bf16 v[32:47], v[120:123], v[220:223], v[32:47]
    v_mfma_f32_32x32x16_bf16 v[48:63], v[124:127], v[220:223], v[48:63]
    s_waitcnt vmcnt(3)
    v_mfma_f32_32x32x16_bf16 v[32:47], v[128:131], v[224:227], v[32:47]
    v_mfma_f32_32x32x16_bf16 v[48:63], v[132:135], v[224:227], v[48:63]
    s_waitcnt vmcnt(2)
    v_mfma_f32_32x32x16_bf16 v[32:47], v[136:139], v[228:231], v[32:47]
    v_mfma_f32_32x32x16_bf16 v[48:63], v[140:143], v[228:231], v[48:63]
    s_waitcnt vmcnt(1)
    v_mfma_f32_32x32x16_bf16 v[32:47], v[144:147], v[232:235], v[32:47]
    v_mfma_f32_32x32x16_bf16 v[48:63], v[148:151], v[232:235], v[48:63]
    s_waitcnt vmcnt(0)
    v_mfma_f32_32x32x16_bf16 v[32:47], v[152:155], v[236:239], v[32:47]
    v_mfma_f32_32x32x16_bf16 v[48:63], v[156:159], v[236:239], v[48:63]
L_tdone:
    v_xor_b32 v17, 32, v24
    v_xor_b32 v18, 64, v24
    v_xor_b32 v19, 96, v24
    v_xor_b32 v20, 128, v24
    v_xor_b32 v21, 160, v24
    v_xor_b32 v22, 192, v24
    v_xor_b32 v23, 224, v24
    v_mov_b32 v16, v24
    s_nop 3
    ds_write_b128 v16, v[32:35]
    ds_write_b128 v17, v[36:39]
    ds_write_b128 v18, v[40:43]
    ds_write_b128 v19, v[44:47]
    ds_write_b128 v20, v[48:51]
    ds_write_b128 v21, v[52:55]
    ds_write_b128 v22, v[56:59]
    ds_write_b128 v23, v[60:63]
    s_waitcnt lgkmcnt(0)
    s_barrier
    ds_read_b128 v[64:67], v25 offset:0
    ds_read_b128 v[68:71], v25 offset:8192
    ds_read_b128 v[72:75], v25 offset:16384
    ds_read_b128 v[76:79], v25 offset:24576
    ds_read_b128 v[80:83], v25 offset:32768
    ds_read_b128 v[84:87], v25 offset:40960
    ds_read_b128 v[88:91], v25 offset:49152
    ds_read_b128 v[92:95], v25 offset:57344
    s_waitcnt lgkmcnt(6)
    v_pk_add_f32 v[64:65], v[64:65], v[68:69]
    v_pk_add_f32 v[66:67], v[66:67], v[70:71]
    s_waitcnt lgkmcnt(4)
    v_pk_add_f32 v[72:73], v[72:73], v[76:77]
    v_pk_add_f32 v[74:75], v[74:75], v[78:79]
    s_waitcnt lgkmcnt(2)
    v_pk_add_f32 v[80:81], v[80:81], v[84:85]
    v_pk_add_f32 v[82:83], v[82:83], v[86:87]
    s_waitcnt lgkmcnt(0)
    v_pk_add_f32 v[88:89], v[88:89], v[92:93]
    v_pk_add_f32 v[90:91], v[90:91], v[94:95]
    v_pk_add_f32 v[64:65], v[64:65], v[72:73]
    v_pk_add_f32 v[66:67], v[66:67], v[74:75]
    v_pk_add_f32 v[80:81], v[80:81], v[88:89]
    v_pk_add_f32 v[82:83], v[82:83], v[90:91]
    v_pk_add_f32 v[64:65], v[64:65], v[80:81]
    v_pk_add_f32 v[66:67], v[66:67], v[82:83]
    v_cvt_pk_bf16_f32 v96, v64, v65
    v_cvt_pk_bf16_f32 v97, v66, v67
    buffer_store_dwordx2 v[96:97], v26, s[56:59], s43 offen sc1
    s_endpgm
L_done:
    s_endpgm
L_hsetup:

    v_lshrrev_b32 v12, 5, v10
    v_bfe_u32 v11, v10, 2, 2
    v_lshl_add_u32 v13, v12, 2, v11
    v_lshlrev_b32 v14, 7, v13
    v_lshrrev_b32 v13, 1, v11
    v_lshl_add_u32 v14, v13, 6, v14
    v_bfe_u32 v13, v10, 4, 1
    v_lshl_add_u32 v14, v13, 5, v14
    v_and_b32 v13, 3, v10
    v_lshl_add_u32 v14, v13, 3, v14
    s_lshl_b32 s47, s46, 13

    s_add_u32 s18, s47, 0x18000
    v_add_u32 v27, s18, v14
    v_xor_b32 v31, 64, v27

    v_lshrrev_b32 v12, 3, v10
    v_cmp_lt_u32 vcc, 2, v12
    v_addc_co_u32 v12, vcc, 0, v12, vcc
    v_and_b32 v13, 7, v10
    v_lshlrev_b32 v13, 4, v13
    v_lshl_add_u32 v8, v12, 7, v13

    v_add_u32 v9, 4096, v8
    v_mov_b32 v15, 0

    v_lshrrev_b32 v12, 3, v10
    v_and_b32 v13, 7, v10
    v_bfe_u32 v14, v10, 4, 1
    v_lshlrev_b32 v14, 2, v14
    v_xor_b32 v14, v14, v13
    v_lshlrev_b32 v14, 4, v14
    v_lshl_add_u32 v32, v12, 10, v14
    s_lshl_b32 s18, s46, 16
    v_add_u32 v32, s18, v32

    v_add_u32 v33, 7168, v32
    v_add_u32 v34, 14336, v32
    v_add_u32 v35, 21504, v32
    v_add_u32 v36, 32768, v32
    v_add_u32 v37, 39936, v32
    v_add_u32 v38, 47104, v32
    v_add_u32 v39, 54272, v32
    s_waitcnt lgkmcnt(0)

    s_lshl_b32 s18, s45, 7
    s_add_u32 s48, s10, s18
    s_addc_u32 s49, s11, 0
    s_sub_u32 s50, 1835008, s18
    s_mov_b32 s51, 0x20000

    s_mov_b32 s52, s14
    s_mov_b32 s53, s15
    s_mov_b32 s54, 256
    s_mov_b32 s55, 0x20000

    s_mov_b32 s28, s16
    s_mov_b32 s29, s17
    s_mov_b32 s30, 8404992
    s_mov_b32 s31, 0x20000

    s_mov_b32 s56, s12
    s_mov_b32 s57, s13
    s_mov_b32 s58, 0x100000
    s_mov_b32 s59, 0x20000
    s_lshl_b32 s43, s44, 15
    s_lshl_b32 s19, s45, 7
    s_add_u32 s43, s43, s19

    s_lshr_b32 s18, s44, 1
    s_lshl_b32 s18, s18, 2
    s_add_u32 s18, s18, s46
    s_mul_i32 s18, s18, 256
    s_add_u32 s18, s18, 8388608
    v_bfe_u32 v12, v10, 1, 2

    v_lshrrev_b32 v13, 1, v12
    v_mul_u32_u24 v13, 3, v13
    v_add_u32 v12, v12, v13

    v_add_u32 v12, s3, v12
    v_subrev_u32 v13, 7, v12
    v_min_u32 v12, v12, v13
    v_and_b32 v13, 1, v10
    v_lshl_add_u32 v12, v12, 1, v13
    v_lshlrev_b32 v12, 3, v12
    v_add_u32 v30, s18, v12

    s_mov_b32 s39, s37

    s_mul_i32 s18, s44, 112
    s_lshl_b32 s19, s46, 2
    s_add_u32 s18, s18, s19
    s_mul_i32 s18, s18, 2048

    s_add_u32 s19, s3, 0
    s_sub_u32 s33, s19, 7
    s_cselect_b32 s19, s19, s33
    s_mul_i32 s19, s19, 32768
    s_add_u32 s33, s18, s19

    s_add_u32 s19, s3, 1
    s_sub_u32 s34, s19, 7
    s_cselect_b32 s19, s19, s34
    s_mul_i32 s19, s19, 32768
    s_add_u32 s34, s18, s19

    s_add_u32 s19, s3, 5
    s_sub_u32 s35, s19, 7
    s_cselect_b32 s19, s19, s35
    s_mul_i32 s19, s19, 32768
    s_add_u32 s35, s18, s19

    s_add_u32 s19, s3, 6
    s_sub_u32 s37, s19, 7
    s_cselect_b32 s19, s19, s37
    s_mul_i32 s19, s19, 32768
    s_add_u32 s37, s18, s19

    v_and_b32 v11, 31, v10
    v_lshrrev_b32 v12, 5, v10
    v_and_b32 v13, 3, v11
    v_bfe_u32 v14, v11, 2, 1
    v_mul_u32_u24 v14, 12, v14
    v_or_b32 v13, v13, v14
    v_xor_b32 v13, v13, v12
    v_lshlrev_b32 v13, 4, v13
    v_lshl_add_u32 v13, v11, 8, v13
    s_lshl_b32 s18, s32, 13
    s_add_u32 s18, s18, 0x10000
    v_add_u32 v24, s18, v13
    v_lshrrev_b32 v11, 4, v10
    s_lshl_b32 s18, s32, 2
    v_add_u32 v11, s18, v11
    v_and_b32 v12, 15, v10
    v_and_b32 v13, 3, v11
    v_bfe_u32 v14, v11, 2, 1
    v_mul_u32_u24 v14, 12, v14
    v_or_b32 v13, v13, v14
    v_xor_b32 v13, v13, v12
    v_lshlrev_b32 v13, 4, v13
    v_lshl_add_u32 v13, v11, 8, v13
    v_add_u32 v25, 0x10000, v13
    v_lshlrev_b32 v26, 10, v11
    v_lshl_add_u32 v26, v12, 3, v26

    s_lshl_b32 s66, s3, 18
    s_waitcnt vmcnt(0)
    s_add_u32 m0, s47, 98304
    s_nop 0
    buffer_load_dwordx4 v32, s[48:51], s66 offen lds
    s_waitcnt vmcnt(0)
    buffer_load_dwordx4 v33, s[48:51], s66 offen offset:1024 lds
    s_waitcnt vmcnt(0)
    buffer_load_dwordx4 v34, s[48:51], s66 offen offset:2048 lds
    s_waitcnt vmcnt(0)
    buffer_load_dwordx4 v35, s[48:51], s66 offen offset:3072 lds
    s_waitcnt vmcnt(0)
    s_addk_i32 m0, 0x1000
    s_nop 0
    buffer_load_dwordx4 v36, s[48:51], s66 offen lds
    s_waitcnt vmcnt(0)
    buffer_load_dwordx4 v37, s[48:51], s66 offen offset:1024 lds
    s_waitcnt vmcnt(0)
    buffer_load_dwordx4 v38, s[48:51], s66 offen offset:2048 lds
    s_waitcnt vmcnt(0)
    buffer_load_dwordx4 v39, s[48:51], s66 offen offset:3072 lds

    s_add_u32 s66, s66, 262144
    s_cmp_eq_u32 s66, 1835008
    s_cselect_b32 s66, 0, s66

    s_branch L_after_p0
.p2align 12
L_compute:

    s_and_b32 s40, s32, 1
    s_lshr_b32 s39, s32, 1

    s_and_b32 s44, s35, 1
    s_xor_b32 s44, s44, 1
    s_lshl_b32 s44, s44, 1
    s_bfe_u32 s45, s35, 0x10001
    s_add_u32 s44, s44, s45

    s_lshl_b32 s44, s44, 3
    s_add_u32 s44, s44, s38
    s_lshr_b32 s45, s35, 2
    s_lshl_b32 s45, s45, 2
    s_add_u32 s45, s45, s37

    s_cmp_eq_u32 s38, 7
    s_cselect_b32 s3, 0, s38

    v_lshrrev_b32 v12, 5, v10
    v_bfe_u32 v11, v10, 2, 2
    v_lshl_add_u32 v13, v12, 2, v11
    v_lshlrev_b32 v14, 7, v13
    v_lshrrev_b32 v13, 1, v11
    v_lshl_add_u32 v14, v13, 6, v14
    v_bfe_u32 v13, v10, 4, 1
    v_lshl_add_u32 v14, v13, 5, v14
    v_and_b32 v13, 3, v10
    v_lshl_add_u32 v14, v13, 3, v14
    s_lshl_b32 s47, s46, 13

    v_add_u32 v160, s47, v14
    v_xor_b32 v161, 64, v160
    v_add_u32 v162, 0x8000, v160
    v_add_u32 v163, 0x8000, v161

    v_lshrrev_b32 v12, 3, v10
    v_cmp_lt_u32 vcc, 2, v12
    v_addc_co_u32 v12, vcc, 0, v12, vcc
    v_and_b32 v13, 7, v10
    v_lshlrev_b32 v13, 4, v13
    v_lshl_add_u32 v8, v12, 7, v13

    v_add_u32 v9, 4096, v8
    v_mov_b32 v15, 0

    v_lshrrev_b32 v12, 5, v10
    v_and_b32 v11, 31, v10
    v_bfe_u32 v13, v10, 1, 3
    v_xor_b32 v13, v13, v12
    v_lshlrev_b32 v13, 4, v13
    v_lshl_add_u32 v3, v11, 7, v13
    s_lshl_b32 s41, s39, 13
    v_add_u32 v3, s41, v3
    v_xor_b32 v4, 32, v3
    v_xor_b32 v5, 64, v3
    v_xor_b32 v6, 96, v3
    v_bfe_u32 v11, v10, 2, 2
    v_lshl_add_u32 v13, v12, 3, v11
    v_lshlrev_b32 v7, 7, v13
    v_lshrrev_b32 v13, 1, v11
    v_xor_b32 v13, s40, v13
    v_lshl_add_u32 v7, v13, 6, v7
    v_bfe_u32 v13, v10, 4, 1
    v_lshl_add_u32 v7, v13, 5, v7
    v_and_b32 v13, 3, v10
    v_lshl_add_u32 v7, v13, 3, v7
    v_add_u32 v7, 0x4000, v7

    s_lshr_b32 s18, s44, 1
    s_lshl_b32 s18, s18, 2
    s_add_u32 s18, s18, s46
    s_mul_i32 s18, s18, 256
    s_add_u32 s18, s18, 8388608
    v_bfe_u32 v12, v10, 1, 2

    v_max_u32 v12, 1, v12
    v_add_u32 v12, 1, v12

    v_add_u32 v12, s3, v12
    v_subrev_u32 v13, 7, v12
    v_min_u32 v12, v12, v13
    v_and_b32 v13, 1, v10
    v_lshl_add_u32 v12, v12, 1, v13
    v_lshlrev_b32 v12, 3, v12
    v_add_u32 v164, s18, v12

    v_and_b32 v11, 31, v10
    v_lshrrev_b32 v12, 5, v10
    v_and_b32 v13, 3, v11
    v_bfe_u32 v14, v11, 2, 1
    v_mul_u32_u24 v14, 12, v14
    v_or_b32 v13, v13, v14
    v_xor_b32 v13, v13, v12
    v_lshlrev_b32 v13, 4, v13
    v_lshl_add_u32 v13, v11, 8, v13
    s_lshl_b32 s18, s32, 13
    s_add_u32 s18, s18, 0x10000
    v_add_u32 v165, s18, v13
    v_lshrrev_b32 v11, 4, v10
    s_lshl_b32 s18, s32, 2
    v_add_u32 v11, s18, v11
    v_and_b32 v12, 15, v10
    v_and_b32 v13, 3, v11
    v_bfe_u32 v14, v11, 2, 1
    v_mul_u32_u24 v14, 12, v14
    v_or_b32 v13, v13, v14
    v_xor_b32 v13, v13, v12
    v_lshlrev_b32 v13, 4, v13
    v_lshl_add_u32 v13, v11, 8, v13
    v_add_u32 v166, 0x10000, v13
    v_lshlrev_b32 v167, 10, v11
    v_lshl_add_u32 v167, v12, 3, v167

    s_lshl_b32 s41, s33, 2
    s_lshl_b32 s42, s39, 1
    s_add_u32 s41, s41, s42
    s_mul_i32 s41, s41, 112
    s_lshl_b32 s42, s34, 2
    s_add_u32 s41, s41, s42
    s_lshl_b32 s42, s40, 1
    s_add_u32 s41, s41, s42
    s_mul_i32 s41, s41, 2048
    s_mov_b32 s68, 0xbfb8aa3b
    s_mov_b32 s69, 0xbfb8aa3b
    s_mov_b32 s66, 1.0
    s_mov_b32 s67, 1.0
    s_lshl_b32 s64, s33, 1
    s_add_u32 s64, s64, s39
    s_lshl_b32 s64, s64, 2
    s_and_b32 s42, s34, 3
    s_add_u32 s64, s64, s42
    s_mul_i32 s64, s64, 256
    s_lshr_b32 s42, s34, 2
    s_lshl_b32 s42, s42, 1
    s_add_u32 s42, s42, s40
    s_lshl_b32 s42, s42, 3
    s_add_u32 s64, s64, s42
    s_add_u32 s64, s64, 8388608
    s_add_u32 s42, s41, 229376

    s_cmp_eq_u32 s37, 3
    s_cselect_b32 s39, 0, s37
    s_add_u32 s39, s39, 4

    s_mul_i32 s18, s44, 112
    s_lshl_b32 s19, s46, 2
    s_add_u32 s18, s18, s19
    s_mul_i32 s18, s18, 2048

    s_add_u32 s19, s3, 2
    s_sub_u32 s34, s19, 7
    s_cselect_b32 s19, s19, s34
    s_mul_i32 s19, s19, 32768
    s_add_u32 s34, s18, s19

    s_add_u32 s19, s3, 3
    s_sub_u32 s35, s19, 7
    s_cselect_b32 s19, s19, s35
    s_mul_i32 s19, s19, 32768
    s_add_u32 s35, s18, s19

    s_add_u32 s19, s3, 4
    s_sub_u32 s37, s19, 7
    s_cselect_b32 s19, s19, s37
    s_mul_i32 s19, s19, 32768
    s_add_u32 s37, s18, s19

    v_mov_b64 v[64:65], 0
    v_mov_b64 v[66:67], 0
    v_mov_b64 v[68:69], 0
    v_mov_b64 v[70:71], 0
    v_mov_b64 v[72:73], 0
    v_mov_b64 v[74:75], 0
    v_mov_b64 v[76:77], 0
    v_mov_b64 v[78:79], 0
    v_mov_b64 v[80:81], 0
    v_mov_b64 v[82:83], 0
    v_mov_b64 v[84:85], 0
    v_mov_b64 v[86:87], 0
    v_mov_b64 v[88:89], 0
    v_mov_b64 v[90:91], 0
    v_mov_b64 v[92:93], 0
    v_mov_b64 v[94:95], 0
    v_mov_b64 v[96:97], 0
    v_mov_b64 v[98:99], 0
    v_mov_b64 v[100:101], 0
    v_mov_b64 v[102:103], 0
    v_mov_b64 v[104:105], 0
    v_mov_b64 v[106:107], 0
    v_mov_b64 v[108:109], 0
    v_mov_b64 v[110:111], 0
    v_mov_b64 v[112:113], 0
    v_mov_b64 v[114:115], 0
    v_mov_b64 v[116:117], 0
    v_mov_b64 v[118:119], 0
    v_mov_b64 v[120:121], 0
    v_mov_b64 v[122:123], 0
    v_mov_b64 v[124:125], 0
    v_mov_b64 v[126:127], 0

    v_mov_b32 v48, v5
    v_mov_b32 v49, v6
    v_mov_b32 v50, v7
    v_add_u32 v51, 0x8000, v3
    v_add_u32 v52, 0x8000, v4
    v_add_u32 v53, 0x8000, v7
    s_mov_b32 s20, 0x8000
    s_mov_b32 s21, 8

    s_waitcnt lgkmcnt(0)

    s_lshl_b32 s18, s45, 7
    s_add_u32 s48, s10, s18
    s_addc_u32 s49, s11, 0
    s_sub_u32 s50, 1835008, s18
    s_mov_b32 s51, 0x20000

    s_mov_b32 s52, s14
    s_mov_b32 s53, s15
    s_mov_b32 s54, 256
    s_mov_b32 s55, 0x20000

    s_mov_b32 s28, s16
    s_mov_b32 s29, s17
    s_mov_b32 s30, 8404992
    s_mov_b32 s31, 0x20000

    s_mov_b32 s56, s12
    s_mov_b32 s57, s13
    s_mov_b32 s58, 0x100000
    s_mov_b32 s59, 0x20000
    s_lshl_b32 s43, s44, 15
    s_lshl_b32 s19, s45, 7
    s_add_u32 s43, s43, s19

    s_cmp_ge_u32 s36, 28
    s_cbranch_scc1 L_c_helper

    s_or_b32 s18, s2, s32
    s_cmp_lg_u32 s18, 0
    s_cbranch_scc1 L_c_start
    s_memrealtime s[18:19]
    s_waitcnt lgkmcnt(0)
    s_or_b32 s18, s18, 1
    v_mov_b32 v16, s18
    v_mov_b32 v17, s19
    s_mov_b64 exec, 1
    buffer_store_dwordx2 v[16:17], v15, s[52:55], 0 offen sc1
    s_mov_b64 exec, -1

L_c_start:
    s_barrier
    ds_read_b64_tr_b16 v[24:25], v7 offset:0
    ds_read_b64_tr_b16 v[26:27], v7 offset:512
    ds_read_b128 v[16:19], v3
    ds_read_b128 v[20:23], v3 offset:4096
    ds_read_b64_tr_b16 v[28:29], v7 offset:8192
    ds_read_b64_tr_b16 v[30:31], v7 offset:8704
    ds_read_b64_tr_b16 v[40:41], v7 offset:2048
    ds_read_b64_tr_b16 v[42:43], v7 offset:2560
    ds_read_b128 v[32:35], v4
    ds_read_b128 v[36:39], v4 offset:4096
    ds_read_b64_tr_b16 v[44:45], v7 offset:10240
    ds_read_b64_tr_b16 v[46:47], v7 offset:10752
    buffer_load_dword v61, v15, s[28:31], s41 offen offset:1536
    buffer_load_dword v61, v15, s[28:31], s64 offen offset:128
    buffer_load_dword v61, v15, s[28:31], s34 offen offset:1536
    buffer_load_dword v61, v15, s[56:59], s43 offen
L_cloop:
    s_waitcnt lgkmcnt(9)
    v_mfma_f32_32x32x16_bf16 v[64:79], v[24:27], v[16:19], v[64:79]
    s_waitcnt lgkmcnt(8)
    v_mfma_f32_32x32x16_bf16 v[96:111], v[24:27], v[20:23], v[96:111]
    ds_read_b64_tr_b16 v[24:25], v50 offset:4096
    ds_read_b64_tr_b16 v[26:27], v50 offset:4608
    s_waitcnt lgkmcnt(8)
    v_mfma_f32_32x32x16_bf16 v[80:95], v[28:31], v[16:19], v[80:95]
    ds_read_b128 v[16:19], v48
    v_mfma_f32_32x32x16_bf16 v[112:127], v[28:31], v[20:23], v[112:127]
    ds_read_b128 v[20:23], v48 offset:4096
    ds_read_b64_tr_b16 v[28:29], v50 offset:12288
    ds_read_b64_tr_b16 v[30:31], v50 offset:12800
    s_waitcnt lgkmcnt(9)
    v_mfma_f32_32x32x16_bf16 v[64:79], v[40:43], v[32:35], v[64:79]
    s_waitcnt lgkmcnt(8)
    v_mfma_f32_32x32x16_bf16 v[96:111], v[40:43], v[36:39], v[96:111]
    ds_read_b64_tr_b16 v[40:41], v50 offset:6144
    ds_read_b64_tr_b16 v[42:43], v50 offset:6656
    s_waitcnt lgkmcnt(8)
    v_mfma_f32_32x32x16_bf16 v[80:95], v[44:47], v[32:35], v[80:95]
    ds_read_b128 v[32:35], v49
    v_mfma_f32_32x32x16_bf16 v[112:127], v[44:47], v[36:39], v[112:127]
    ds_read_b128 v[36:39], v49 offset:4096
    ds_read_b64_tr_b16 v[44:45], v50 offset:14336
    ds_read_b64_tr_b16 v[46:47], v50 offset:14848
    s_waitcnt lgkmcnt(9)
    v_mfma_f32_32x32x16_bf16 v[64:79], v[24:27], v[16:19], v[64:79]
    v_add_u32 v48, s20, v5
    v_add_u32 v49, s20, v6
    s_waitcnt lgkmcnt(8)
    v_mfma_f32_32x32x16_bf16 v[96:111], v[24:27], v[20:23], v[96:111]
    s_barrier
    ds_read_b64_tr_b16 v[24:25], v53 offset:0
    ds_read_b64_tr_b16 v[26:27], v53 offset:512
    s_waitcnt lgkmcnt(8)
    v_mfma_f32_32x32x16_bf16 v[80:95], v[28:31], v[16:19], v[80:95]
    ds_read_b128 v[16:19], v51
    v_mfma_f32_32x32x16_bf16 v[112:127], v[28:31], v[20:23], v[112:127]
    ds_read_b128 v[20:23], v51 offset:4096
    ds_read_b64_tr_b16 v[28:29], v53 offset:8192
    ds_read_b64_tr_b16 v[30:31], v53 offset:8704
    v_add_u32 v50, s20, v7
    s_add_u32 s20, s20, 0x8000
    s_sub_u32 s18, s20, 0x28000
    s_cselect_b32 s20, s20, s18
    s_waitcnt lgkmcnt(9)
    v_mfma_f32_32x32x16_bf16 v[64:79], v[40:43], v[32:35], v[64:79]
    s_sub_u32 s21, s21, 1
    v_add_u32 v51, s20, v3
    s_waitcnt lgkmcnt(8)
    v_mfma_f32_32x32x16_bf16 v[96:111], v[40:43], v[36:39], v[96:111]
    ds_read_b64_tr_b16 v[40:41], v53 offset:2048
    ds_read_b64_tr_b16 v[42:43], v53 offset:2560
    s_waitcnt lgkmcnt(8)
    v_mfma_f32_32x32x16_bf16 v[80:95], v[44:47], v[32:35], v[80:95]
    ds_read_b128 v[32:35], v52
    v_mfma_f32_32x32x16_bf16 v[112:127], v[44:47], v[36:39], v[112:127]
    ds_read_b128 v[36:39], v52 offset:4096
    ds_read_b64_tr_b16 v[44:45], v53 offset:10240
    ds_read_b64_tr_b16 v[46:47], v53 offset:10752
    v_add_u32 v52, s20, v4
    v_add_u32 v53, s20, v7
    s_cmp_lg_u32 s21, 0
    s_cbranch_scc1 L_cloop
    s_waitcnt lgkmcnt(0)
    s_barrier
    buffer_load_dwordx2 v[58:59], v15, s[52:55], 0 offen sc1
    s_nop 7
    s_nop 3
    v_pk_mul_f32 v[16:17], s[68:69], v[64:65]
    v_pk_mul_f32 v[18:19], s[68:69], v[66:67]
    v_pk_mul_f32 v[20:21], s[68:69], v[68:69]
    v_pk_mul_f32 v[22:23], s[68:69], v[70:71]
    v_pk_mul_f32 v[24:25], s[68:69], v[72:73]
    v_pk_mul_f32 v[26:27], s[68:69], v[74:75]
    v_pk_mul_f32 v[28:29], s[68:69], v[76:77]
    v_pk_mul_f32 v[30:31], s[68:69], v[78:79]
    v_exp_f32 v16, v16
    v_exp_f32 v17, v17
    v_exp_f32 v18, v18
    v_exp_f32 v19, v19
    v_exp_f32 v20, v20
    v_exp_f32 v21, v21
    v_exp_f32 v22, v22
    v_exp_f32 v23, v23
    v_exp_f32 v24, v24
    v_exp_f32 v25, v25
    v_exp_f32 v26, v26
    v_exp_f32 v27, v27
    v_exp_f32 v28, v28
    v_exp_f32 v29, v29
    v_exp_f32 v30, v30
    v_exp_f32 v31, v31
    v_pk_mul_f32 v[64:65], v[64:65], v[80:81]
    v_pk_mul_f32 v[66:67], v[66:67], v[82:83]
    v_pk_mul_f32 v[68:69], v[68:69], v[84:85]
    v_pk_mul_f32 v[70:71], v[70:71], v[86:87]
    v_pk_mul_f32 v[72:73], v[72:73], v[88:89]
    v_pk_mul_f32 v[74:75], v[74:75], v[90:91]
    v_pk_mul_f32 v[76:77], v[76:77], v[92:93]
    v_pk_mul_f32 v[78:79], v[78:79], v[94:95]
    v_pk_add_f32 v[16:17], s[66:67], v[16:17]
    v_pk_add_f32 v[18:19], s[66:67], v[18:19]
    v_pk_add_f32 v[20:21], s[66:67], v[20:21]
    v_pk_add_f32 v[22:23], s[66:67], v[22:23]
    v_pk_add_f32 v[24:25], s[66:67], v[24:25]
    v_pk_add_f32 v[26:27], s[66:67], v[26:27]
    v_pk_add_f32 v[28:29], s[66:67], v[28:29]
    v_pk_add_f32 v[30:31], s[66:67], v[30:31]
    v_rcp_f32 v16, v16
    v_rcp_f32 v17, v17
    v_rcp_f32 v18, v18
    v_rcp_f32 v19, v19
    v_rcp_f32 v20, v20
    v_rcp_f32 v21, v21
    v_rcp_f32 v22, v22
    v_rcp_f32 v23, v23
    v_rcp_f32 v24, v24
    v_rcp_f32 v25, v25
    v_rcp_f32 v26, v26
    v_rcp_f32 v27, v27
    v_rcp_f32 v28, v28
    v_rcp_f32 v29, v29
    v_rcp_f32 v30, v30
    v_rcp_f32 v31, v31
    s_nop 0
    v_pk_mul_f32 v[64:65], v[64:65], v[16:17]
    v_pk_mul_f32 v[66:67], v[66:67], v[18:19]
    v_pk_mul_f32 v[68:69], v[68:69], v[20:21]
    v_pk_mul_f32 v[70:71], v[70:71], v[22:23]
    v_pk_mul_f32 v[72:73], v[72:73], v[24:25]
    v_pk_mul_f32 v[74:75], v[74:75], v[26:27]
    v_pk_mul_f32 v[76:77], v[76:77], v[28:29]
    v_pk_mul_f32 v[78:79], v[78:79], v[30:31]
    v_cvt_pk_bf16_f32 v32, v64, v65
    v_cvt_pk_bf16_f32 v33, v66, v67
    v_cvt_pk_bf16_f32 v34, v68, v69
    v_cvt_pk_bf16_f32 v35, v70, v71
    v_cvt_pk_bf16_f32 v36, v72, v73
    v_cvt_pk_bf16_f32 v37, v74, v75
    v_cvt_pk_bf16_f32 v38, v76, v77
    v_cvt_pk_bf16_f32 v39, v78, v79
    buffer_store_dwordx4 v[32:35], v8, s[28:31], s41 offen sc1
    buffer_store_dwordx4 v[36:39], v8, s[28:31], s41 offen offset:2048 sc1
    v_pk_mul_f32 v[16:17], s[68:69], v[96:97]
    v_pk_mul_f32 v[18:19], s[68:69], v[98:99]
    v_pk_mul_f32 v[20:21], s[68:69], v[100:101]
    v_pk_mul_f32 v[22:23], s[68:69], v[102:103]
    v_pk_mul_f32 v[24:25], s[68:69], v[104:105]
    v_pk_mul_f32 v[26:27], s[68:69], v[106:107]
    v_pk_mul_f32 v[28:29], s[68:69], v[108:109]
    v_pk_mul_f32 v[30:31], s[68:69], v[110:111]
    v_exp_f32 v16, v16
    v_exp_f32 v17, v17
    v_exp_f32 v18, v18
    v_exp_f32 v19, v19
    v_exp_f32 v20, v20
    v_exp_f32 v21, v21
    v_exp_f32 v22, v22
    v_exp_f32 v23, v23
    v_exp_f32 v24, v24
    v_exp_f32 v25, v25
    v_exp_f32 v26, v26
    v_exp_f32 v27, v27
    v_exp_f32 v28, v28
    v_exp_f32 v29, v29
    v_exp_f32 v30, v30
    v_exp_f32 v31, v31
    v_pk_mul_f32 v[96:97], v[96:97], v[112:113]
    v_pk_mul_f32 v[98:99], v[98:99], v[114:115]
    v_pk_mul_f32 v[100:101], v[100:101], v[116:117]
    v_pk_mul_f32 v[102:103], v[102:103], v[118:119]
    v_pk_mul_f32 v[104:105], v[104:105], v[120:121]
    v_pk_mul_f32 v[106:107], v[106:107], v[122:123]
    v_pk_mul_f32 v[108:109], v[108:109], v[124:125]
    v_pk_mul_f32 v[110:111], v[110:111], v[126:127]
    v_pk_add_f32 v[16:17], s[66:67], v[16:17]
    v_pk_add_f32 v[18:19], s[66:67], v[18:19]
    v_pk_add_f32 v[20:21], s[66:67], v[20:21]
    v_pk_add_f32 v[22:23], s[66:67], v[22:23]
    v_pk_add_f32 v[24:25], s[66:67], v[24:25]
    v_pk_add_f32 v[26:27], s[66:67], v[26:27]
    v_pk_add_f32 v[28:29], s[66:67], v[28:29]
    v_pk_add_f32 v[30:31], s[66:67], v[30:31]
    v_rcp_f32 v16, v16
    v_rcp_f32 v17, v17
    v_rcp_f32 v18, v18
    v_rcp_f32 v19, v19
    v_rcp_f32 v20, v20
    v_rcp_f32 v21, v21
    v_rcp_f32 v22, v22
    v_rcp_f32 v23, v23
    v_rcp_f32 v24, v24
    v_rcp_f32 v25, v25
    v_rcp_f32 v26, v26
    v_rcp_f32 v27, v27
    v_rcp_f32 v28, v28
    v_rcp_f32 v29, v29
    v_rcp_f32 v30, v30
    v_rcp_f32 v31, v31
    s_nop 0
    v_pk_mul_f32 v[96:97], v[96:97], v[16:17]
    v_pk_mul_f32 v[98:99], v[98:99], v[18:19]
    v_pk_mul_f32 v[100:101], v[100:101], v[20:21]
    v_pk_mul_f32 v[102:103], v[102:103], v[22:23]
    v_pk_mul_f32 v[104:105], v[104:105], v[24:25]
    v_pk_mul_f32 v[106:107], v[106:107], v[26:27]
    v_pk_mul_f32 v[108:109], v[108:109], v[28:29]
    v_pk_mul_f32 v[110:111], v[110:111], v[30:31]
    v_cvt_pk_bf16_f32 v40, v96, v97
    v_cvt_pk_bf16_f32 v41, v98, v99
    v_cvt_pk_bf16_f32 v42, v100, v101
    v_cvt_pk_bf16_f32 v43, v102, v103
    v_cvt_pk_bf16_f32 v44, v104, v105
    v_cvt_pk_bf16_f32 v45, v106, v107
    v_cvt_pk_bf16_f32 v46, v108, v109
    v_cvt_pk_bf16_f32 v47, v110, v111
    buffer_store_dwordx4 v[40:43], v8, s[28:31], s42 offen sc1
    buffer_store_dwordx4 v[44:47], v8, s[28:31], s42 offen offset:2048 sc1
    v_mov_b32 v20, v160
    v_mov_b32 v21, v161
    v_mov_b32 v27, v162
    v_mov_b32 v31, v163
    v_mov_b32 v30, v164
    v_mov_b32 v24, v165
    v_mov_b32 v25, v166
    v_mov_b32 v26, v167
    s_waitcnt vmcnt(0)
    v_mov_b64 v[28:29], v[58:59]
    s_movk_i32 s19, 2000
L_nC:
    v_readfirstlane_b32 s18, v28
    s_cmp_lg_u32 s18, 0
    s_cbranch_scc1 L_nokC
    s_sub_u32 s19, s19, 1
    s_cmp_eq_u32 s19, 0
    s_cbranch_scc1 L_nokC
    buffer_load_dwordx2 v[28:29], v15, s[52:55], 0 offen sc1
    s_waitcnt vmcnt(0)
    s_branch L_nC
L_nokC:
    s_mov_b64 exec, 1
    buffer_store_dwordx2 v[28:29], v15, s[28:31], s64 offen sc1
    s_mov_b64 exec, -1
L_c_common:
    buffer_load_dwordx2 v[16:17], v30, s[28:31], 0 offen sc1
    v_mov_b64 v[32:33], 0
    v_mov_b64 v[34:35], 0
    v_mov_b64 v[36:37], 0
    v_mov_b64 v[38:39], 0
    v_mov_b64 v[40:41], 0
    v_mov_b64 v[42:43], 0
    v_mov_b64 v[44:45], 0
    v_mov_b64 v[46:47], 0
    v_mov_b64 v[48:49], 0
    v_mov_b64 v[50:51], 0
    v_mov_b64 v[52:53], 0
    v_mov_b64 v[54:55], 0
    v_mov_b64 v[56:57], 0
    v_mov_b64 v[58:59], 0
    v_mov_b64 v[60:61], 0
    v_mov_b64 v[62:63], 0
    s_mov_b32 s60, 0x54
    s_mov_b32 s63, 0x54
    s_mov_b32 s65, 1
    s_barrier
    s_branch L_tail
L_c_helper:
    v_mov_b32 v20, v160
    v_mov_b32 v21, v161
    v_mov_b32 v27, v162
    v_mov_b32 v31, v163
    v_mov_b32 v30, v164
    v_mov_b32 v24, v165
    v_mov_b32 v25, v166
    v_mov_b32 v26, v167
    s_barrier
    buffer_load_dwordx2 v[28:29], v15, s[52:55], 0 offen sc1
    s_waitcnt vmcnt(0)
    s_movk_i32 s19, 2000
L_nH:
    v_readfirstlane_b32 s18, v28
    s_cmp_lg_u32 s18, 0
    s_cbranch_scc1 L_nokH
    s_sub_u32 s19, s19, 1
    s_cmp_eq_u32 s19, 0
    s_cbranch_scc1 L_nokH
    buffer_load_dwordx2 v[28:29], v15, s[52:55], 0 offen sc1
    s_waitcnt vmcnt(0)
    s_branch L_nH
L_nokH:
    s_branch L_c_common

.section .rodata,"a"
.p2align 6
.amdhsa_kernel standalone__glu_gated_swiglu__sampling_kernel
  .amdhsa_next_free_vgpr 256
  .amdhsa_next_free_sgpr 100
  .amdhsa_accum_offset 256
  .amdhsa_group_segment_fixed_size 0
  .amdhsa_kernarg_size 56
  .amdhsa_user_sgpr_count 2
  .amdhsa_user_sgpr_kernarg_segment_ptr 1
  .amdhsa_system_sgpr_workgroup_id_x 1
.end_amdhsa_kernel
```
